```python
import torch

def _softmax(x, axis=-1):
    return torch.softmax(x, dim=axis)
def _gelu(x):
    return torch.nn.functional.gelu(x, approximate="tanh")
def _silu(x):
    return torch.nn.functional.silu(x)
def _sigmoid(x):
    return torch.sigmoid(x)
def _layernorm(x, axis=-1, eps=1e-5):
    m = x.mean(dim=axis, keepdim=True)
    v = x.var(dim=axis, keepdim=True, unbiased=False)
    return (x - m) / torch.sqrt(v + eps)
def _scatter_add(tgt, idx, src, axis=0):
    return tgt.clone().index_add_(axis, idx, src)
def _segment_sum(src, seg, n):
    out = torch.zeros((n,) + src.shape[1:], dtype=src.dtype)
    return out.index_add_(0, seg, src)
def _pad(x, pw):
    flat = tuple(v for pair in reversed(pw) for v in pair)
    return torch.nn.functional.pad(x, flat)

kernel_name = 'concat_heads__sliding_block_cached__sliding_block_cached__decode'

def setup_inputs():

    _w = (lambda a: (lambda t: t.to(torch.bfloat16) if t.is_floating_point() else t)(torch.as_tensor(a)))
    def _A_setup():
        B, Sq, D = 2, 1, 512
        Hq, Hkv, Sk, Dh = 32, 8, 8192, 128
        assert Hq % Hkv == 0, (Hq, Hkv)
        return {
            "x": _w((lambda *s: torch.randn(*s, dtype=torch.bfloat16) * 0.8)(B, Sq, D)),
            "k_cache": _w((lambda *s: torch.randn(*s, dtype=torch.bfloat16) * 0.8)(B, Hkv, Sk, Dh)),
            "v_cache": _w((lambda *s: torch.randn(*s, dtype=torch.bfloat16) * 0.05)(B, Hkv, Sk, Dh)),
            "wq": _w((lambda *s: torch.randn(*s, dtype=torch.bfloat16) * 0.8)(D, Hq * Dh) * (D ** -0.5)),
            "wo": _w((lambda *s: torch.randn(*s, dtype=torch.bfloat16) * 0.05)(Hq * Dh, D) * ((Hq * Dh) ** -0.5)),
        }
    _A_in = _A_setup()

    def _B_setup():
        B, Sq, D = 2, 1, 512
        Hq, Hkv, Sk, Dh = 32, 8, 8192, 128
        assert Hq % Hkv == 0, (Hq, Hkv)
        return {
            "x": _w((lambda *s: torch.randn(*s, dtype=torch.bfloat16) * 0.8)(B, Sq, D)),
            "k_cache": _w((lambda *s: torch.randn(*s, dtype=torch.bfloat16) * 0.8)(B, Hkv, Sk, Dh)),
            "v_cache": _w((lambda *s: torch.randn(*s, dtype=torch.bfloat16) * 0.05)(B, Hkv, Sk, Dh)),
            "wq": _w((lambda *s: torch.randn(*s, dtype=torch.bfloat16) * 0.8)(D, Hq * Dh) * (D ** -0.5)),
            "wo": _w((lambda *s: torch.randn(*s, dtype=torch.bfloat16) * 0.05)(Hq * Dh, D) * ((Hq * Dh) ** -0.5)),
        }
    _B_in = _B_setup()

    return {
        "A_x": _A_in["x"],
        "A_k_cache": _A_in["k_cache"],
        "A_v_cache": _A_in["v_cache"],
        "A_wq": _A_in["wq"],
        "A_wo": _A_in["wo"],
        "B_x": _B_in["x"],
        "B_k_cache": _B_in["k_cache"],
        "B_v_cache": _B_in["v_cache"],
        "B_wq": _B_in["wq"],
        "B_wo": _B_in["wo"],
    }

def reference(A_x, A_k_cache, A_v_cache, A_wq, A_wo, B_x, B_k_cache, B_v_cache, B_wq, B_wo):
    def _A_ref(x, k_cache, v_cache, wq, wo):
        B, Sq, D = x.shape
        Hq, Dh = 32, 128
        Hkv, Sk = k_cache.shape[1], k_cache.shape[2]
        W = min(4096, max(256, Sk // 4))
        rep = Hq // Hkv
        q = (lambda x, *d: x.permute(*d))((x @ wq).reshape(B, Sq, Hq, Dh), 0, 2, 1, 3)
        k = (lambda x, n, axis: torch.repeat_interleave(x, n, dim=axis))(k_cache[:, :, Sk - W:, :], rep, axis=1)
        v = (lambda x, n, axis: torch.repeat_interleave(x, n, dim=axis))(v_cache[:, :, Sk - W:, :], rep, axis=1)
        scores = torch.einsum("bhqd,bhkd->bhqk", q, k) * (Dh ** -0.5)
        p = _softmax(scores, axis=-1)
        o = torch.einsum("bhqk,bhkd->bhqd", p, v)
        return (lambda x, *d: x.permute(*d))(o, 0, 2, 1, 3).reshape(B, Sq, Hq * Dh) @ wo

    def _B_ref(x, k_cache, v_cache, wq, wo):
        B, Sq, D = x.shape
        Hq, Dh = 32, 128
        Hkv, Sk = k_cache.shape[1], k_cache.shape[2]
        W = min(4096, max(256, Sk // 4))
        rep = Hq // Hkv
        q = (lambda x, *d: x.permute(*d))((x @ wq).reshape(B, Sq, Hq, Dh), 0, 2, 1, 3)
        k = (lambda x, n, axis: torch.repeat_interleave(x, n, dim=axis))(k_cache[:, :, Sk - W:, :], rep, axis=1)
        v = (lambda x, n, axis: torch.repeat_interleave(x, n, dim=axis))(v_cache[:, :, Sk - W:, :], rep, axis=1)
        scores = torch.einsum("bhqd,bhkd->bhqk", q, k) * (Dh ** -0.5)
        p = _softmax(scores, axis=-1)
        o = torch.einsum("bhqk,bhkd->bhqd", p, v)
        return (lambda x, *d: x.permute(*d))(o, 0, 2, 1, 3).reshape(B, Sq, Hq * Dh) @ wo

    a = _A_ref(A_x, A_k_cache, A_v_cache, A_wq, A_wo)
    b = _B_ref(B_x, B_k_cache, B_v_cache, B_wq, B_wo)
    return torch.concatenate([a, b], axis=-1)
```

```asm
; @launch grid=(256,1,1) block=(320,1,1) lds=49152
.amdgcn_target "amdgcn-amd-amdhsa--gfx950"
.text
.globl concat_heads__sliding_block_cached__sliding_block_cached__decode_kernel
.p2align 8
.type concat_heads__sliding_block_cached__sliding_block_cached__decode_kernel,@function
concat_heads__sliding_block_cached__sliding_block_cached__decode_kernel:
    s_cmp_ge_u32 s2, 256
    s_cbranch_scc1 L_end
    s_and_b32 s3, s2, 15
    s_lshr_b32 s4, s2, 4
    s_lshr_b32 s5, s3, 3
    s_and_b32 s6, s3, 7
    s_mul_i32 s7, s5, 40
    s_add_u32 s8, s0, s7
    s_addc_u32 s9, s1, 0
    s_load_dwordx4 s[12:15], s[8:9], 0
    s_load_dwordx4 s[16:19], s[8:9], 16
    s_load_dwordx2 s[20:21], s[8:9], 32
    s_load_dwordx2 s[24:25], s[0:1], 80
    s_load_dwordx2 s[22:23], s[0:1], 96
    v_and_b32 v1, 63, v0
    v_lshrrev_b32 v20, 6, v0
    v_lshrrev_b32 v2, 4, v1
    v_readfirstlane_b32 s26, v20
    v_and_b32 v3, 15, v1
    s_lshr_b32 s27, s4, 3
    s_and_b32 s28, s4, 7
    s_lshr_b32 s29, s4, 2
    s_and_b32 s30, s4, 3
    s_lshl_b32 s31, s6, 2
    s_add_u32 s31, s31, s29
    s_lshl_b32 s10, s3, 4
    s_add_u32 s10, s10, s4
    s_cmp_lg_u32 s26, 0
    s_cbranch_scc1 L_awave
    s_lshl_b32 s37, s30, 7
    s_lshl_b32 s39, s37, 13
    s_lshl_b32 s7, s31, 8
    s_add_u32 s39, s39, s7
    v_lshlrev_b32 v4, 18, v2
    v_lshl_add_u32 v4, v3, 4, v4
    v_add_u32 v4, s39, v4
    v_lshrrev_b32 v20, 3, v3
    v_lshlrev_b32 v5, 10, v20
    v_lshl_add_u32 v5, v2, 6, v5
    s_lshl_b32 s37, s37, 1
    v_add_u32 v5, s37, v5
    s_mov_b32 s42, 2048
    s_mov_b32 s43, 0x20000
    s_mov_b32 s54, 0x400000
    s_mov_b32 s55, 0x20000
    s_mov_b32 s68, 0
    s_waitcnt lgkmcnt(0)
    s_mov_b32 s40, s12
    s_mov_b32 s41, s13
    s_mov_b32 s52, s18
    s_mov_b32 s53, s19
    buffer_load_dwordx4 v[38:41], v5, s[40:43], 0 offen
    buffer_load_dwordx4 v[42:45], v5, s[40:43], 0 offen offset:16
    buffer_load_dwordx4 v[46:49], v5, s[40:43], 0 offen offset:32
    buffer_load_dwordx4 v[50:53], v5, s[40:43], 0 offen offset:48
    buffer_load_dwordx4 a[0:3], v4, s[52:55], s68 offen nt
    s_add_u32 s68, s68, 8192
    buffer_load_dwordx4 a[4:7], v4, s[52:55], s68 offen nt
    s_add_u32 s68, s68, 8192
    buffer_load_dwordx4 a[8:11], v4, s[52:55], s68 offen nt
    s_add_u32 s68, s68, 8192
    buffer_load_dwordx4 a[12:15], v4, s[52:55], s68 offen nt
    s_add_u32 s68, s68, 8192
    buffer_load_dwordx4 a[16:19], v4, s[52:55], s68 offen nt
    s_add_u32 s68, s68, 8192
    buffer_load_dwordx4 a[20:23], v4, s[52:55], s68 offen nt
    s_add_u32 s68, s68, 8192
    buffer_load_dwordx4 a[24:27], v4, s[52:55], s68 offen nt
    s_add_u32 s68, s68, 8192
    buffer_load_dwordx4 a[28:31], v4, s[52:55], s68 offen nt
    s_add_u32 s68, s68, 8192
    buffer_load_dwordx4 a[32:35], v4, s[52:55], s68 offen nt
    s_add_u32 s68, s68, 8192
    buffer_load_dwordx4 a[36:39], v4, s[52:55], s68 offen nt
    s_add_u32 s68, s68, 8192
    buffer_load_dwordx4 a[40:43], v4, s[52:55], s68 offen nt
    s_add_u32 s68, s68, 8192
    buffer_load_dwordx4 a[44:47], v4, s[52:55], s68 offen nt
    s_add_u32 s68, s68, 8192
    buffer_load_dwordx4 a[48:51], v4, s[52:55], s68 offen nt
    s_add_u32 s68, s68, 8192
    buffer_load_dwordx4 a[52:55], v4, s[52:55], s68 offen nt
    s_add_u32 s68, s68, 8192
    buffer_load_dwordx4 a[56:59], v4, s[52:55], s68 offen nt
    s_add_u32 s68, s68, 8192
    buffer_load_dwordx4 a[60:63], v4, s[52:55], s68 offen nt
    s_add_u32 s68, s68, 8192
    buffer_load_dwordx4 a[64:67], v4, s[52:55], s68 offen nt
    s_add_u32 s68, s68, 8192
    buffer_load_dwordx4 a[68:71], v4, s[52:55], s68 offen nt
    s_add_u32 s68, s68, 8192
    buffer_load_dwordx4 a[72:75], v4, s[52:55], s68 offen nt
    s_add_u32 s68, s68, 8192
    buffer_load_dwordx4 a[76:79], v4, s[52:55], s68 offen nt
    s_add_u32 s68, s68, 8192
    buffer_load_dwordx4 a[80:83], v4, s[52:55], s68 offen nt
    s_add_u32 s68, s68, 8192
    buffer_load_dwordx4 a[84:87], v4, s[52:55], s68 offen nt
    s_add_u32 s68, s68, 8192
    buffer_load_dwordx4 a[88:91], v4, s[52:55], s68 offen nt
    s_add_u32 s68, s68, 8192
    buffer_load_dwordx4 a[92:95], v4, s[52:55], s68 offen nt
    s_add_u32 s68, s68, 8192
    buffer_load_dwordx4 a[96:99], v4, s[52:55], s68 offen nt
    s_add_u32 s68, s68, 8192
    buffer_load_dwordx4 a[100:103], v4, s[52:55], s68 offen nt
    s_add_u32 s68, s68, 8192
    buffer_load_dwordx4 a[104:107], v4, s[52:55], s68 offen nt
    s_add_u32 s68, s68, 8192
    buffer_load_dwordx4 a[108:111], v4, s[52:55], s68 offen nt
    s_add_u32 s68, s68, 8192
    buffer_load_dwordx4 a[112:115], v4, s[52:55], s68 offen nt
    s_add_u32 s68, s68, 8192
    buffer_load_dwordx4 a[116:119], v4, s[52:55], s68 offen nt
    s_add_u32 s68, s68, 8192
    buffer_load_dwordx4 a[120:123], v4, s[52:55], s68 offen nt
    s_add_u32 s68, s68, 8192
    buffer_load_dwordx4 a[124:127], v4, s[52:55], s68 offen nt
    s_barrier
    s_lshl_b32 s7, s5, 7
    s_add_u32 s88, s22, s7
    s_addc_u32 s89, s23, 0
    s_load_dword s32, s[88:89], 0
    s_mov_b32 s34, 0xfff
    s_mov_b32 s96, 100000
    s_mov_b32 s60, s22
    s_mov_b32 s61, s23
    s_mov_b32 s62, 0x400000
    s_mov_b32 s63, 0x20000
    v_and_b32 v20, 1, v3
    v_bfe_u32 v21, v3, 1, 2
    v_mov_b32 v22, 0x0c0c0100
    v_mov_b32 v70, 0x01000c0c
    v_cmp_eq_u32 vcc, 0, v20
    v_mov_b32 v71, 0x0c0c0302
    v_mov_b32 v72, 0x03020c0c
    v_cndmask_b32 v70, v70, v22, vcc
    v_cndmask_b32 v71, v72, v71, vcc
    v_mov_b32 v22, 0x0c0c0c0c
    v_cmp_eq_u32 vcc, 0, v21
    s_nop 1
    v_cndmask_b32 v8, v22, v70, vcc
    v_cndmask_b32 v12, v22, v71, vcc
    v_cmp_eq_u32 vcc, 1, v21
    s_nop 1
    v_cndmask_b32 v9, v22, v70, vcc
    v_cndmask_b32 v13, v22, v71, vcc
    v_cmp_eq_u32 vcc, 2, v21
    s_nop 1
    v_cndmask_b32 v10, v22, v70, vcc
    v_cndmask_b32 v14, v22, v71, vcc
    v_cmp_eq_u32 vcc, 3, v21
    s_nop 1
    v_cndmask_b32 v11, v22, v70, vcc
    v_cndmask_b32 v15, v22, v71, vcc
    v_bfe_u32 v20, v1, 2, 2
    v_lshlrev_b32 v115, 12, v20
    v_lshl_add_u32 v115, v2, 6, v115
    v_and_b32 v20, 3, v1
    v_lshl_add_u32 v115, v20, 4, v115
    s_lshl_b32 s37, s3, 14
    s_lshl_b32 s38, s27, 9
    s_add_u32 s37, s37, s38
    s_add_u32 s37, s37, 65536
    v_add_u32 v115, s37, v115
    s_lshl_b32 s37, s10, 10
    s_add_u32 s37, s37, 65536
    v_lshlrev_b32 v108, 4, v1
    v_add_u32 v102, s37, v108
    s_mov_b32 s72, 0
    s_mov_b32 s73, 1024
    s_mov_b32 s74, 2048
    s_mov_b32 s75, 3072
    v_lshlrev_b32 v20, 1, v2
    v_sub_u32 v20, v3, v20
    v_and_b32 v21, 15, v20
    v_xor_b32 v22, 8, v21
    v_lshlrev_b32 v20, 10, v2
    v_lshl_add_u32 v6, v21, 4, v20
    v_lshl_add_u32 v7, v22, 4, v20
    s_mov_b32 s56, s20
    s_mov_b32 s57, s21
    s_mov_b32 s58, 0x400000
    s_mov_b32 s59, 0x20000
    s_lshl_b32 s11, s31, 17
    s_lshl_b32 s38, s30, 8
    s_add_u32 s11, s11, s38
    s_waitcnt lgkmcnt(0)
    s_add_u32 s33, s32, 1
    v_mov_b32 v23, s33
    s_and_b32 s35, s33, 0xfff
    s_mov_b32 s92, 8
    s_mov_b32 s79, 2097152
    s_waitcnt vmcnt(32)
    v_perm_b32 v70, v38, v38, v8
    v_perm_b32 v71, v38, v38, v9
    v_perm_b32 v72, v38, v38, v10
    v_perm_b32 v73, v38, v38, v11
    v_perm_b32 v74, v38, v38, v12
    v_perm_b32 v75, v38, v38, v13
    v_perm_b32 v76, v38, v38, v14
    v_perm_b32 v77, v38, v38, v15
    s_waitcnt vmcnt(31)
    v_mfma_f32_16x16x32_bf16 v[30:33], v[70:73], a[0:3], 0
    v_perm_b32 v70, v39, v39, v8
    v_perm_b32 v71, v39, v39, v9
    v_perm_b32 v72, v39, v39, v10
    v_perm_b32 v73, v39, v39, v11
    s_waitcnt vmcnt(30)
    v_mfma_f32_16x16x32_bf16 v[30:33], v[74:77], a[4:7], v[30:33]
    v_perm_b32 v74, v39, v39, v12
    v_perm_b32 v75, v39, v39, v13
    v_perm_b32 v76, v39, v39, v14
    v_perm_b32 v77, v39, v39, v15
    s_waitcnt vmcnt(29)
    v_mfma_f32_16x16x32_bf16 v[30:33], v[70:73], a[8:11], v[30:33]
    v_perm_b32 v70, v40, v40, v8
    v_perm_b32 v71, v40, v40, v9
    v_perm_b32 v72, v40, v40, v10
    v_perm_b32 v73, v40, v40, v11
    s_waitcnt vmcnt(28)
    v_mfma_f32_16x16x32_bf16 v[30:33], v[74:77], a[12:15], v[30:33]
    v_perm_b32 v74, v40, v40, v12
    v_perm_b32 v75, v40, v40, v13
    v_perm_b32 v76, v40, v40, v14
    v_perm_b32 v77, v40, v40, v15
    s_waitcnt vmcnt(27)
    v_mfma_f32_16x16x32_bf16 v[30:33], v[70:73], a[16:19], v[30:33]
    v_perm_b32 v70, v41, v41, v8
    v_perm_b32 v71, v41, v41, v9
    v_perm_b32 v72, v41, v41, v10
    v_perm_b32 v73, v41, v41, v11
    s_waitcnt vmcnt(26)
    v_mfma_f32_16x16x32_bf16 v[30:33], v[74:77], a[20:23], v[30:33]
    v_perm_b32 v74, v41, v41, v12
    v_perm_b32 v75, v41, v41, v13
    v_perm_b32 v76, v41, v41, v14
    v_perm_b32 v77, v41, v41, v15
    s_waitcnt vmcnt(25)
    v_mfma_f32_16x16x32_bf16 v[30:33], v[70:73], a[24:27], v[30:33]
    v_perm_b32 v70, v42, v42, v8
    v_perm_b32 v71, v42, v42, v9
    v_perm_b32 v72, v42, v42, v10
    v_perm_b32 v73, v42, v42, v11
    s_waitcnt vmcnt(24)
    s_barrier
    v_mfma_f32_16x16x32_bf16 v[30:33], v[74:77], a[28:31], v[30:33]
    v_perm_b32 v74, v42, v42, v12
    v_perm_b32 v75, v42, v42, v13
    v_perm_b32 v76, v42, v42, v14
    v_perm_b32 v77, v42, v42, v15
    s_waitcnt vmcnt(23)
    v_mfma_f32_16x16x32_bf16 v[30:33], v[70:73], a[32:35], v[30:33]
    v_perm_b32 v70, v43, v43, v8
    v_perm_b32 v71, v43, v43, v9
    v_perm_b32 v72, v43, v43, v10
    v_perm_b32 v73, v43, v43, v11
    s_waitcnt vmcnt(22)
    v_mfma_f32_16x16x32_bf16 v[30:33], v[74:77], a[36:39], v[30:33]
    v_perm_b32 v74, v43, v43, v12
    v_perm_b32 v75, v43, v43, v13
    v_perm_b32 v76, v43, v43, v14
    v_perm_b32 v77, v43, v43, v15
    s_waitcnt vmcnt(21)
    v_mfma_f32_16x16x32_bf16 v[30:33], v[70:73], a[40:43], v[30:33]
    v_perm_b32 v70, v44, v44, v8
    v_perm_b32 v71, v44, v44, v9
    v_perm_b32 v72, v44, v44, v10
    v_perm_b32 v73, v44, v44, v11
    s_waitcnt vmcnt(20)
    v_mfma_f32_16x16x32_bf16 v[30:33], v[74:77], a[44:47], v[30:33]
    v_perm_b32 v74, v44, v44, v12
    v_perm_b32 v75, v44, v44, v13
    v_perm_b32 v76, v44, v44, v14
    v_perm_b32 v77, v44, v44, v15
    s_waitcnt vmcnt(19)
    v_mfma_f32_16x16x32_bf16 v[30:33], v[70:73], a[48:51], v[30:33]
    v_perm_b32 v70, v45, v45, v8
    v_perm_b32 v71, v45, v45, v9
    v_perm_b32 v72, v45, v45, v10
    v_perm_b32 v73, v45, v45, v11
    s_waitcnt vmcnt(18)
    v_mfma_f32_16x16x32_bf16 v[30:33], v[74:77], a[52:55], v[30:33]
    v_perm_b32 v74, v45, v45, v12
    v_perm_b32 v75, v45, v45, v13
    v_perm_b32 v76, v45, v45, v14
    v_perm_b32 v77, v45, v45, v15
    s_waitcnt vmcnt(17)
    v_mfma_f32_16x16x32_bf16 v[30:33], v[70:73], a[56:59], v[30:33]
    v_perm_b32 v70, v46, v46, v8
    v_perm_b32 v71, v46, v46, v9
    v_perm_b32 v72, v46, v46, v10
    v_perm_b32 v73, v46, v46, v11
    s_waitcnt vmcnt(16)
    s_barrier
    v_mfma_f32_16x16x32_bf16 v[30:33], v[74:77], a[60:63], v[30:33]
    v_perm_b32 v74, v46, v46, v12
    v_perm_b32 v75, v46, v46, v13
    v_perm_b32 v76, v46, v46, v14
    v_perm_b32 v77, v46, v46, v15
    s_waitcnt vmcnt(15)
    v_mfma_f32_16x16x32_bf16 v[30:33], v[70:73], a[64:67], v[30:33]
    v_perm_b32 v70, v47, v47, v8
    v_perm_b32 v71, v47, v47, v9
    v_perm_b32 v72, v47, v47, v10
    v_perm_b32 v73, v47, v47, v11
    s_waitcnt vmcnt(14)
    v_mfma_f32_16x16x32_bf16 v[30:33], v[74:77], a[68:71], v[30:33]
    v_perm_b32 v74, v47, v47, v12
    v_perm_b32 v75, v47, v47, v13
    v_perm_b32 v76, v47, v47, v14
    v_perm_b32 v77, v47, v47, v15
    s_waitcnt vmcnt(13)
    v_mfma_f32_16x16x32_bf16 v[30:33], v[70:73], a[72:75], v[30:33]
    v_perm_b32 v70, v48, v48, v8
    v_perm_b32 v71, v48, v48, v9
    v_perm_b32 v72, v48, v48, v10
    v_perm_b32 v73, v48, v48, v11
    s_waitcnt vmcnt(12)
    v_mfma_f32_16x16x32_bf16 v[30:33], v[74:77], a[76:79], v[30:33]
    v_perm_b32 v74, v48, v48, v12
    v_perm_b32 v75, v48, v48, v13
    v_perm_b32 v76, v48, v48, v14
    v_perm_b32 v77, v48, v48, v15
    s_waitcnt vmcnt(11)
    v_mfma_f32_16x16x32_bf16 v[30:33], v[70:73], a[80:83], v[30:33]
    v_perm_b32 v70, v49, v49, v8
    v_perm_b32 v71, v49, v49, v9
    v_perm_b32 v72, v49, v49, v10
    v_perm_b32 v73, v49, v49, v11
    s_waitcnt vmcnt(10)
    v_mfma_f32_16x16x32_bf16 v[30:33], v[74:77], a[84:87], v[30:33]
    v_perm_b32 v74, v49, v49, v12
    v_perm_b32 v75, v49, v49, v13
    v_perm_b32 v76, v49, v49, v14
    v_perm_b32 v77, v49, v49, v15
    s_waitcnt vmcnt(9)
    v_mfma_f32_16x16x32_bf16 v[30:33], v[70:73], a[88:91], v[30:33]
    v_perm_b32 v70, v50, v50, v8
    v_perm_b32 v71, v50, v50, v9
    v_perm_b32 v72, v50, v50, v10
    v_perm_b32 v73, v50, v50, v11
    s_waitcnt vmcnt(8)
    s_barrier
    v_mfma_f32_16x16x32_bf16 v[30:33], v[74:77], a[92:95], v[30:33]
    v_perm_b32 v74, v50, v50, v12
    v_perm_b32 v75, v50, v50, v13
    v_perm_b32 v76, v50, v50, v14
    v_perm_b32 v77, v50, v50, v15
    s_waitcnt vmcnt(7)
    v_mfma_f32_16x16x32_bf16 v[30:33], v[70:73], a[96:99], v[30:33]
    v_perm_b32 v70, v51, v51, v8
    v_perm_b32 v71, v51, v51, v9
    v_perm_b32 v72, v51, v51, v10
    v_perm_b32 v73, v51, v51, v11
    s_waitcnt vmcnt(6)
    v_mfma_f32_16x16x32_bf16 v[30:33], v[74:77], a[100:103], v[30:33]
    v_perm_b32 v74, v51, v51, v12
    v_perm_b32 v75, v51, v51, v13
    v_perm_b32 v76, v51, v51, v14
    v_perm_b32 v77, v51, v51, v15
    s_waitcnt vmcnt(5)
    v_mfma_f32_16x16x32_bf16 v[30:33], v[70:73], a[104:107], v[30:33]
    v_perm_b32 v70, v52, v52, v8
    v_perm_b32 v71, v52, v52, v9
    v_perm_b32 v72, v52, v52, v10
    v_perm_b32 v73, v52, v52, v11
    s_waitcnt vmcnt(4)
    v_mfma_f32_16x16x32_bf16 v[30:33], v[74:77], a[108:111], v[30:33]
    v_perm_b32 v74, v52, v52, v12
    v_perm_b32 v75, v52, v52, v13
    v_perm_b32 v76, v52, v52, v14
    v_perm_b32 v77, v52, v52, v15
    s_waitcnt vmcnt(3)
    v_mfma_f32_16x16x32_bf16 v[30:33], v[70:73], a[112:115], v[30:33]
    v_perm_b32 v70, v53, v53, v8
    v_perm_b32 v71, v53, v53, v9
    v_perm_b32 v72, v53, v53, v10
    v_perm_b32 v73, v53, v53, v11
    s_waitcnt vmcnt(2)
    v_mfma_f32_16x16x32_bf16 v[30:33], v[74:77], a[116:119], v[30:33]
    v_perm_b32 v74, v53, v53, v12
    v_perm_b32 v75, v53, v53, v13
    v_perm_b32 v76, v53, v53, v14
    v_perm_b32 v77, v53, v53, v15
    s_waitcnt vmcnt(1)
    v_mfma_f32_16x16x32_bf16 v[30:33], v[70:73], a[120:123], v[30:33]
    s_nop 1
    s_waitcnt vmcnt(0)
    v_mfma_f32_16x16x32_bf16 v[30:33], v[74:77], a[124:127], v[30:33]
    s_nop 7
    v_bfi_b32 v30, s34, v23, v30
    v_bfi_b32 v31, s34, v23, v31
    v_bfi_b32 v32, s34, v23, v32
    v_bfi_b32 v33, s34, v23, v33
    buffer_store_dwordx4 v[30:33], v102, s[60:63], 0 offen
    buffer_store_dwordx4 v[30:33], v102, s[60:63], s79 offen sc1
    v_mov_b32 v104, 1024
    s_mov_b32 s81, 17
L_q_w0:
    ds_read_b32 v20, v104
    s_sub_u32 s96, s96, 1
    s_cbranch_scc1 L_q_okA
    s_waitcnt lgkmcnt(0)
    v_readfirstlane_b32 s37, v20
    s_cmp_lt_u32 s37, s81
    s_cbranch_scc1 L_q_w0
    buffer_load_dwordx4 v[70:73], v115, s[60:63], s72 offen sc1
    buffer_load_dwordx4 v[74:77], v115, s[60:63], s72 offen offset:256 sc1
    buffer_load_dwordx4 v[78:81], v115, s[60:63], s73 offen sc1
    buffer_load_dwordx4 v[82:85], v115, s[60:63], s73 offen offset:256 sc1
    buffer_load_dwordx4 v[86:89], v115, s[60:63], s74 offen sc1
    buffer_load_dwordx4 v[90:93], v115, s[60:63], s74 offen offset:256 sc1
    buffer_load_dwordx4 v[94:97], v115, s[60:63], s75 offen sc1
    buffer_load_dwordx4 v[98:101], v115, s[60:63], s75 offen offset:256 sc1
L_q_loop:
    s_add_u32 s81, s81, 4
L_q_w1:
    ds_read_b32 v20, v104
    s_sub_u32 s96, s96, 1
    s_cbranch_scc1 L_q_okA
    s_waitcnt lgkmcnt(0)
    v_readfirstlane_b32 s37, v20
    s_cmp_lt_u32 s37, s81
    s_cbranch_scc1 L_q_w1
    buffer_load_dwordx4 v[38:41], v115, s[60:63], s72 offen sc1
    buffer_load_dwordx4 v[42:45], v115, s[60:63], s72 offen offset:256 sc1
    buffer_load_dwordx4 v[46:49], v115, s[60:63], s73 offen sc1
    buffer_load_dwordx4 v[50:53], v115, s[60:63], s73 offen offset:256 sc1
    buffer_load_dwordx4 v[54:57], v115, s[60:63], s74 offen sc1
    buffer_load_dwordx4 v[58:61], v115, s[60:63], s74 offen offset:256 sc1
    buffer_load_dwordx4 v[62:65], v115, s[60:63], s75 offen sc1
    buffer_load_dwordx4 v[66:69], v115, s[60:63], s75 offen offset:256 sc1
    s_waitcnt vmcnt(8)
    v_xor_b32 v20, s35, v70
    v_xor_b32 v21, s35, v71
    v_xor_b32 v22, s35, v72
    v_or3_b32 v20, v20, v21, v22
    v_xor_b32 v21, s35, v73
    v_xor_b32 v22, s35, v74
    v_or3_b32 v20, v20, v21, v22
    v_xor_b32 v21, s35, v75
    v_xor_b32 v22, s35, v76
    v_or3_b32 v20, v20, v21, v22
    v_xor_b32 v21, s35, v77
    v_xor_b32 v22, s35, v78
    v_or3_b32 v20, v20, v21, v22
    v_xor_b32 v21, s35, v79
    v_xor_b32 v22, s35, v80
    v_or3_b32 v20, v20, v21, v22
    v_xor_b32 v21, s35, v81
    v_xor_b32 v22, s35, v82
    v_or3_b32 v20, v20, v21, v22
    v_xor_b32 v21, s35, v83
    v_xor_b32 v22, s35, v84
    v_or3_b32 v20, v20, v21, v22
    v_xor_b32 v21, s35, v85
    v_xor_b32 v22, s35, v86
    v_or3_b32 v20, v20, v21, v22
    v_xor_b32 v21, s35, v87
    v_xor_b32 v22, s35, v88
    v_or3_b32 v20, v20, v21, v22
    v_xor_b32 v21, s35, v89
    v_xor_b32 v22, s35, v90
    v_or3_b32 v20, v20, v21, v22
    v_xor_b32 v21, s35, v91
    v_xor_b32 v22, s35, v92
    v_or3_b32 v20, v20, v21, v22
    v_xor_b32 v21, s35, v93
    v_xor_b32 v22, s35, v94
    v_or3_b32 v20, v20, v21, v22
    v_xor_b32 v21, s35, v95
    v_xor_b32 v22, s35, v96
    v_or3_b32 v20, v20, v21, v22
    v_xor_b32 v21, s35, v97
    v_xor_b32 v22, s35, v98
    v_or3_b32 v20, v20, v21, v22
    v_xor_b32 v21, s35, v99
    v_xor_b32 v22, s35, v100
    v_or3_b32 v20, v20, v21, v22
    v_xor_b32 v21, s35, v101
    v_or_b32 v20, v20, v21
    v_and_b32 v20, s34, v20
    v_cmp_ne_u32 vcc, 0, v20
    s_cbranch_vccz L_q_okA
    s_sub_u32 s92, s92, 1
    s_cbranch_scc0 L_qa_noalt
    s_or_b32 s72, s72, 2097152
    s_or_b32 s73, s73, 2097152
    s_or_b32 s74, s74, 2097152
    s_or_b32 s75, s75, 2097152
L_qa_noalt:
    s_add_u32 s81, s81, 4
L_q_w2:
    ds_read_b32 v20, v104
    s_sub_u32 s96, s96, 1
    s_cbranch_scc1 L_q_okA
    s_waitcnt lgkmcnt(0)
    v_readfirstlane_b32 s37, v20
    s_cmp_lt_u32 s37, s81
    s_cbranch_scc1 L_q_w2
    buffer_load_dwordx4 v[70:73], v115, s[60:63], s72 offen sc1
    buffer_load_dwordx4 v[74:77], v115, s[60:63], s72 offen offset:256 sc1
    buffer_load_dwordx4 v[78:81], v115, s[60:63], s73 offen sc1
    buffer_load_dwordx4 v[82:85], v115, s[60:63], s73 offen offset:256 sc1
    buffer_load_dwordx4 v[86:89], v115, s[60:63], s74 offen sc1
    buffer_load_dwordx4 v[90:93], v115, s[60:63], s74 offen offset:256 sc1
    buffer_load_dwordx4 v[94:97], v115, s[60:63], s75 offen sc1
    buffer_load_dwordx4 v[98:101], v115, s[60:63], s75 offen offset:256 sc1
    s_waitcnt vmcnt(8)
    v_xor_b32 v20, s35, v38
    v_xor_b32 v21, s35, v39
    v_xor_b32 v22, s35, v40
    v_or3_b32 v20, v20, v21, v22
    v_xor_b32 v21, s35, v41
    v_xor_b32 v22, s35, v42
    v_or3_b32 v20, v20, v21, v22
    v_xor_b32 v21, s35, v43
    v_xor_b32 v22, s35, v44
    v_or3_b32 v20, v20, v21, v22
    v_xor_b32 v21, s35, v45
    v_xor_b32 v22, s35, v46
    v_or3_b32 v20, v20, v21, v22
    v_xor_b32 v21, s35, v47
    v_xor_b32 v22, s35, v48
    v_or3_b32 v20, v20, v21, v22
    v_xor_b32 v21, s35, v49
    v_xor_b32 v22, s35, v50
    v_or3_b32 v20, v20, v21, v22
    v_xor_b32 v21, s35, v51
    v_xor_b32 v22, s35, v52
    v_or3_b32 v20, v20, v21, v22
    v_xor_b32 v21, s35, v53
    v_xor_b32 v22, s35, v54
    v_or3_b32 v20, v20, v21, v22
    v_xor_b32 v21, s35, v55
    v_xor_b32 v22, s35, v56
    v_or3_b32 v20, v20, v21, v22
    v_xor_b32 v21, s35, v57
    v_xor_b32 v22, s35, v58
    v_or3_b32 v20, v20, v21, v22
    v_xor_b32 v21, s35, v59
    v_xor_b32 v22, s35, v60
    v_or3_b32 v20, v20, v21, v22
    v_xor_b32 v21, s35, v61
    v_xor_b32 v22, s35, v62
    v_or3_b32 v20, v20, v21, v22
    v_xor_b32 v21, s35, v63
    v_xor_b32 v22, s35, v64
    v_or3_b32 v20, v20, v21, v22
    v_xor_b32 v21, s35, v65
    v_xor_b32 v22, s35, v66
    v_or3_b32 v20, v20, v21, v22
    v_xor_b32 v21, s35, v67
    v_xor_b32 v22, s35, v68
    v_or3_b32 v20, v20, v21, v22
    v_xor_b32 v21, s35, v69
    v_or_b32 v20, v20, v21
    v_and_b32 v20, s34, v20
    v_cmp_ne_u32 vcc, 0, v20
    s_cbranch_vccz L_q_okB
    s_sub_u32 s92, s92, 1
    s_cbranch_scc0 L_qb_noalt
    s_or_b32 s72, s72, 2097152
    s_or_b32 s73, s73, 2097152
    s_or_b32 s74, s74, 2097152
    s_or_b32 s75, s75, 2097152
L_qb_noalt:
    s_branch L_q_loop
L_q_okB:
    v_mov_b32 v20, 1
    ds_write_b32 v104, v20 offset:32
    v_add_f32 v38, v38, v46
    v_add_f32 v39, v39, v47
    v_add_f32 v40, v40, v48
    v_add_f32 v41, v41, v49
    v_add_f32 v42, v42, v50
    v_add_f32 v43, v43, v51
    v_add_f32 v44, v44, v52
    v_add_f32 v45, v45, v53
    v_add_f32 v54, v54, v62
    v_add_f32 v55, v55, v63
    v_add_f32 v56, v56, v64
    v_add_f32 v57, v57, v65
    v_add_f32 v58, v58, v66
    v_add_f32 v59, v59, v67
    v_add_f32 v60, v60, v68
    v_add_f32 v61, v61, v69
    v_add_f32 v38, v38, v54
    v_add_f32 v39, v39, v55
    v_add_f32 v40, v40, v56
    v_add_f32 v41, v41, v57
    v_add_f32 v42, v42, v58
    v_add_f32 v43, v43, v59
    v_add_f32 v44, v44, v60
    v_add_f32 v45, v45, v61
    v_cvt_pk_bf16_f32 v26, v38, v39
    v_cvt_pk_bf16_f32 v27, v40, v41
    v_cvt_pk_bf16_f32 v28, v42, v43
    v_cvt_pk_bf16_f32 v29, v44, v45
    s_branch L_q_done
L_q_okA:
    v_mov_b32 v20, 1
    ds_write_b32 v104, v20 offset:32
    v_add_f32 v70, v70, v78
    v_add_f32 v71, v71, v79
    v_add_f32 v72, v72, v80
    v_add_f32 v73, v73, v81
    v_add_f32 v74, v74, v82
    v_add_f32 v75, v75, v83
    v_add_f32 v76, v76, v84
    v_add_f32 v77, v77, v85
    v_add_f32 v86, v86, v94
    v_add_f32 v87, v87, v95
    v_add_f32 v88, v88, v96
    v_add_f32 v89, v89, v97
    v_add_f32 v90, v90, v98
    v_add_f32 v91, v91, v99
    v_add_f32 v92, v92, v100
    v_add_f32 v93, v93, v101
    v_add_f32 v70, v70, v86
    v_add_f32 v71, v71, v87
    v_add_f32 v72, v72, v88
    v_add_f32 v73, v73, v89
    v_add_f32 v74, v74, v90
    v_add_f32 v75, v75, v91
    v_add_f32 v76, v76, v92
    v_add_f32 v77, v77, v93
    v_cvt_pk_bf16_f32 v26, v70, v71
    v_cvt_pk_bf16_f32 v27, v72, v73
    v_cvt_pk_bf16_f32 v28, v74, v75
    v_cvt_pk_bf16_f32 v29, v76, v77
L_q_done:
    ds_write_b128 v108, v[26:29] offset:0
    s_waitcnt lgkmcnt(0)
    s_barrier
    s_mov_b32 m0, 16384
    s_nop 0
    buffer_load_dwordx4 v6, s[56:59], s11 offen nt lds
    s_add_u32 s11, s11, 4096
    s_add_u32 m0, m0, 1024
    s_nop 0
    buffer_load_dwordx4 v6, s[56:59], s11 offen nt lds
    s_add_u32 s11, s11, 4096
    s_add_u32 m0, m0, 1024
    s_nop 0
    buffer_load_dwordx4 v7, s[56:59], s11 offen nt lds
    s_add_u32 s11, s11, 4096
    s_add_u32 m0, m0, 1024
    s_nop 0
    buffer_load_dwordx4 v7, s[56:59], s11 offen nt lds
    s_add_u32 s11, s11, 4096
    s_add_u32 m0, m0, 1024
    s_nop 0
    buffer_load_dwordx4 v6, s[56:59], s11 offen nt lds
    s_add_u32 s11, s11, 4096
    s_add_u32 m0, m0, 1024
    s_nop 0
    buffer_load_dwordx4 v6, s[56:59], s11 offen nt lds
    s_add_u32 s11, s11, 4096
    s_add_u32 m0, m0, 1024
    s_nop 0
    buffer_load_dwordx4 v7, s[56:59], s11 offen nt lds
    s_add_u32 s11, s11, 4096
    s_add_u32 m0, m0, 1024
    s_nop 0
    buffer_load_dwordx4 v7, s[56:59], s11 offen nt lds
    s_add_u32 s11, s11, 4096
    s_add_u32 m0, m0, 1024
    s_nop 0
    buffer_load_dwordx4 v6, s[56:59], s11 offen nt lds
    s_add_u32 s11, s11, 4096
    s_add_u32 m0, m0, 1024
    s_nop 0
    buffer_load_dwordx4 v6, s[56:59], s11 offen nt lds
    s_add_u32 s11, s11, 4096
    s_add_u32 m0, m0, 1024
    s_nop 0
    buffer_load_dwordx4 v7, s[56:59], s11 offen nt lds
    s_add_u32 s11, s11, 4096
    s_add_u32 m0, m0, 1024
    s_nop 0
    buffer_load_dwordx4 v7, s[56:59], s11 offen nt lds
    s_add_u32 s11, s11, 4096
    s_add_u32 m0, m0, 1024
    s_nop 0
    buffer_load_dwordx4 v6, s[56:59], s11 offen nt lds
    s_add_u32 s11, s11, 4096
    s_add_u32 m0, m0, 1024
    s_nop 0
    buffer_load_dwordx4 v6, s[56:59], s11 offen nt lds
    s_add_u32 s11, s11, 4096
    s_add_u32 m0, m0, 1024
    s_nop 0
    buffer_load_dwordx4 v7, s[56:59], s11 offen nt lds
    s_add_u32 s11, s11, 4096
    s_add_u32 m0, m0, 1024
    s_nop 0
    buffer_load_dwordx4 v7, s[56:59], s11 offen nt lds
    s_add_u32 s11, s11, 4096
    s_add_u32 m0, m0, 1024
    s_nop 0
    buffer_load_dwordx4 v6, s[56:59], s11 offen nt lds
    s_add_u32 s11, s11, 4096
    s_add_u32 m0, m0, 1024
    s_nop 0
    buffer_load_dwordx4 v6, s[56:59], s11 offen nt lds
    s_add_u32 s11, s11, 4096
    s_add_u32 m0, m0, 1024
    s_nop 0
    buffer_load_dwordx4 v7, s[56:59], s11 offen nt lds
    s_add_u32 s11, s11, 4096
    s_add_u32 m0, m0, 1024
    s_nop 0
    buffer_load_dwordx4 v7, s[56:59], s11 offen nt lds
    s_add_u32 s11, s11, 4096
    s_add_u32 m0, m0, 1024
    s_nop 0
    buffer_load_dwordx4 v6, s[56:59], s11 offen nt lds
    s_add_u32 s11, s11, 4096
    s_add_u32 m0, m0, 1024
    s_nop 0
    buffer_load_dwordx4 v6, s[56:59], s11 offen nt lds
    s_add_u32 s11, s11, 4096
    s_add_u32 m0, m0, 1024
    s_nop 0
    buffer_load_dwordx4 v7, s[56:59], s11 offen nt lds
    s_add_u32 s11, s11, 4096
    s_add_u32 m0, m0, 1024
    s_nop 0
    buffer_load_dwordx4 v7, s[56:59], s11 offen nt lds
    s_add_u32 s11, s11, 4096
    s_add_u32 m0, m0, 1024
    s_nop 0
    buffer_load_dwordx4 v6, s[56:59], s11 offen nt lds
    s_add_u32 s11, s11, 4096
    s_add_u32 m0, m0, 1024
    s_nop 0
    buffer_load_dwordx4 v6, s[56:59], s11 offen nt lds
    s_add_u32 s11, s11, 4096
    s_add_u32 m0, m0, 1024
    s_nop 0
    buffer_load_dwordx4 v7, s[56:59], s11 offen nt lds
    s_add_u32 s11, s11, 4096
    s_add_u32 m0, m0, 1024
    s_nop 0
    buffer_load_dwordx4 v7, s[56:59], s11 offen nt lds
    s_add_u32 s11, s11, 4096
    s_add_u32 m0, m0, 1024
    s_nop 0
    buffer_load_dwordx4 v6, s[56:59], s11 offen nt lds
    s_add_u32 s11, s11, 4096
    s_add_u32 m0, m0, 1024
    s_nop 0
    buffer_load_dwordx4 v6, s[56:59], s11 offen nt lds
    s_add_u32 s11, s11, 4096
    s_add_u32 m0, m0, 1024
    s_nop 0
    buffer_load_dwordx4 v7, s[56:59], s11 offen nt lds
    s_add_u32 s11, s11, 4096
    s_add_u32 m0, m0, 1024
    s_nop 0
    buffer_load_dwordx4 v7, s[56:59], s11 offen nt lds
    s_barrier
    s_waitcnt vmcnt(0)
    s_barrier
    s_branch L_fin
L_awave:
    s_sub_u32 s26, s26, 1
    s_lshl_b32 s37, s27, 3
    s_add_u32 s37, s37, s6
    s_lshl_b32 s37, s37, 13
    s_add_u32 s37, s37, 6144
    s_lshl_b32 s38, s28, 8
    s_add_u32 s37, s37, s38
    s_lshl_b32 s38, s26, 6
    s_add_u32 s37, s37, s38
    s_lshl_b32 s37, s37, 8
    v_lshlrev_b32 v108, 4, v1
    v_add_u32 v4, s37, v108
    v_bfe_u32 v5, v1, 2, 2
    v_lshlrev_b32 v5, 8, v5
    v_lshl_add_u32 v5, v2, 6, v5
    v_and_b32 v21, 3, v1
    v_lshl_add_u32 v5, v21, 4, v5
    v_add_u32 v5, s37, v5
    s_mov_b32 s46, 0x2000000
    s_mov_b32 s47, 0x20000
    s_mov_b32 s50, 0x2000000
    s_mov_b32 s51, 0x20000
    s_mov_b32 s76, 4096
    s_mov_b32 s77, 8192
    s_mov_b32 s78, 12288
    s_mov_b32 s97, 8192
    s_mov_b32 s80, 0
    v_and_b32 v20, 1, v1
    v_bfe_u32 v21, v1, 1, 1
    v_mov_b32 v22, 0xffff0000
    v_mov_b32 v70, 0x0000ffff
    v_cmp_eq_u32 vcc, 0, v20
    s_nop 1
    v_cndmask_b32 v70, v22, v70, vcc
    v_cmp_eq_u32 vcc, 0, v21
    s_nop 1
    v_cndmask_b32 v16, 0, v70, vcc
    v_cndmask_b32_e64 v17, v70, 0, vcc
    v_mov_b32 v58, 0
    v_mov_b32 v59, 0
    v_mov_b32 v62, 0
    v_mov_b32 v63, 0
    v_mov_b32 v64, 0
    v_mov_b32 v65, 0
    v_mov_b32 v68, 0
    v_mov_b32 v69, 0
    s_lshl_b32 s37, s26, 11
    s_add_u32 s37, s37, 4096
    v_lshlrev_b32 v20, 5, v1
    v_add_u32 v109, s37, v20
    s_lshl_b32 s37, s26, 10
    v_add_u32 v20, s37, v108
    v_add_u32 v114, 4096, v20
    s_lshl_b32 s37, s10, 11
    s_add_u32 s37, s37, 524288
    v_add_u32 v102, s37, v20
    v_bfe_u32 v20, v1, 2, 2
    v_lshlrev_b32 v112, 4, v20
    s_lshl_b32 s37, s3, 10
    s_lshl_b32 s38, s4, 4
    s_add_u32 s37, s37, s38
    s_add_u32 s37, s37, 1048576
    v_lshlrev_b32 v105, 8, v20
    v_add_u32 v105, s37, v105
    s_mov_b64 s[70:71], -1
    s_cmp_lt_u32 s26, 2
    s_cbranch_scc1 L_opub
    v_mov_b32 v102, v105
    s_mov_b64 s[70:71], 0x1111
L_opub:
    s_lshl_b32 s37, s3, 10
    s_lshl_b32 s38, s29, 8
    s_add_u32 s37, s37, s38
    s_lshr_b32 s38, s26, 1
    s_lshl_b32 s38, s38, 7
    s_add_u32 s37, s37, s38
    s_add_u32 s37, s37, 1048576
    v_add_u32 v20, v1, v2
    v_and_b32 v20, 7, v20
    v_lshlrev_b32 v104, 4, v20
    v_add_u32 v104, s37, v104
    v_lshlrev_b32 v103, 11, v2
    v_lshl_add_u32 v103, v3, 4, v103
    s_lshl_b32 s37, s3, 15
    s_lshr_b32 s38, s26, 1
    s_lshl_b32 s38, s38, 14
    s_add_u32 s37, s37, s38
    s_lshl_b32 s38, s29, 9
    s_add_u32 s37, s37, s38
    s_and_b32 s38, s26, 1
    s_lshl_b32 s38, s38, 8
    s_add_u32 s37, s37, s38
    s_add_u32 s37, s37, 524288
    v_add_u32 v103, s37, v103
    s_lshl_b32 s37, s26, 7
    s_add_u32 s37, s37, 2048
    v_lshlrev_b32 v111, 3, v3
    v_add_u32 v111, s37, v111
    v_and_b32 v20, 1, v3
    v_lshlrev_b32 v110, 8, v20
    v_lshl_add_u32 v110, v2, 4, v110
    v_add_u32 v110, 2048, v110
    v_bfe_u32 v20, v1, 2, 2
    v_lshl_add_u32 v21, v2, 3, v20
    v_lshlrev_b32 v116, 8, v21
    v_add_u32 v116, 16384, v116
    v_and_b32 v21, 1, v1
    v_lshl_add_u32 v116, v21, 3, v116
    v_bfe_u32 v21, v1, 1, 1
    v_lshl_add_u32 v21, v20, 1, v21
    v_and_b32 v20, 1, v2
    v_lshl_add_u32 v21, v20, 3, v21
    s_lshl_b32 s37, s26, 2
    v_add_u32 v21, s37, v21
    v_add_u32 v22, 2, v21
    v_and_b32 v21, 15, v21
    v_and_b32 v22, 15, v22
    v_lshl_add_u32 v117, v22, 4, v116
    v_lshl_add_u32 v116, v21, 4, v116
    v_mov_b32 v21, 0
    v_lshlrev_b32 v20, 2, v1
    v_and_b32 v20, 63, v20
    ds_write_b32 v20, v21 offset:1024
    s_lshl_b32 s37, s26, 2
    s_add_u32 s37, s37, 1024
    v_mov_b32 v115, s37
    v_mov_b32 v105, 1056
    v_lshlrev_b32 v20, 2, v1
    v_and_b32 v20, 63, v20
    v_mov_b32 v21, -1
    ds_write_b32 v20, v21 offset:1088
    s_waitcnt lgkmcnt(0)
    s_mov_b32 s44, s14
    s_mov_b32 s45, s15
    s_mov_b32 s48, s16
    s_mov_b32 s49, s17
    s_mov_b32 s64, s24
    s_mov_b32 s65, s25
    s_mov_b32 s66, 4096
    s_mov_b32 s67, 0x20000
    s_mov_b32 s36, 0x3e0293ee
    s_lshl_b32 s7, s5, 7
    s_add_u32 s88, s22, s7
    s_addc_u32 s89, s23, 0
    s_load_dword s32, s[88:89], 0
    s_mov_b32 s34, 0xfff
    s_mov_b32 s96, 100000
    s_mov_b32 s60, s22
    s_mov_b32 s61, s23
    s_mov_b32 s62, 0x400000
    s_mov_b32 s63, 0x20000
    s_barrier
    buffer_load_dwordx4 a[0:3], v5, s[44:47], 0 offen nt
    buffer_load_dwordx4 a[4:7], v5, s[44:47], 0 offen offset:1024 nt
    buffer_load_dwordx4 a[8:11], v5, s[44:47], 0 offen offset:2048 nt
    buffer_load_dwordx4 a[12:15], v5, s[44:47], 0 offen offset:3072 nt
    s_lshl_b32 s37, s5, 2
    s_add_u32 s37, s37, s30
    s_lshl_b32 s37, s37, 15
    s_add_u32 s39, s37, 1114112
    s_lshl_b32 s37, s31, 10
    s_add_u32 s37, s37, s39
    s_lshl_b32 s38, s26, 7
    s_add_u32 s37, s37, s38
    v_lshlrev_b32 v106, 9, v3
    v_lshl_add_u32 v106, v2, 4, v106
    v_add_u32 v106, s37, v106
    v_lshrrev_b32 v20, 1, v1
    v_lshlrev_b32 v107, 10, v20
    v_and_b32 v20, 1, v1
    v_lshl_add_u32 v107, v20, 4, v107
    s_lshl_b32 s37, s31, 5
    s_add_u32 s37, s37, s39
    v_add_u32 v107, s37, v107
    s_lshr_b32 s37, s31, 4
    s_lshl_b32 s37, s37, 10
    s_lshl_b32 s38, s5, 9
    s_add_u32 s37, s37, s38
    s_lshl_b32 s38, s30, 7
    s_add_u32 s37, s37, s38
    s_and_b32 s38, s31, 15
    s_lshl_b32 s38, s38, 3
    s_add_u32 s37, s37, s38
    s_lshl_b32 s37, s37, 1
    v_lshlrev_b32 v113, 3, v20
    v_add_u32 v113, s37, v113
    s_waitcnt lgkmcnt(0)
    s_add_u32 s33, s32, 1
    v_mov_b32 v23, s33
    s_and_b32 s35, s33, 0xfff
    s_mov_b32 s92, 8
    s_mov_b32 s79, 2097152
    s_barrier
    buffer_load_dwordx4 a[16:19], v5, s[44:47], s76 offen nt
    buffer_load_dwordx4 a[20:23], v5, s[44:47], s76 offen offset:1024 nt
    buffer_load_dwordx4 a[24:27], v5, s[44:47], s76 offen offset:2048 nt
    s_barrier
    buffer_load_dwordx4 a[28:31], v5, s[44:47], s76 offen offset:3072 nt
    buffer_load_dwordx4 a[32:35], v5, s[44:47], s77 offen nt
    buffer_load_dwordx4 a[36:39], v5, s[44:47], s77 offen offset:1024 nt
    s_barrier
    buffer_load_dwordx4 a[40:43], v5, s[44:47], s77 offen offset:2048 nt
    buffer_load_dwordx4 a[44:47], v5, s[44:47], s77 offen offset:3072 nt
    ds_read_b32 v21, v105
    s_waitcnt vmcnt(11)
    buffer_load_dwordx4 a[48:51], v5, s[44:47], s78 offen nt
    v_mov_b32 v20, 13
    ds_write_b32 v115, v20
    s_waitcnt lgkmcnt(1)
    v_readfirstlane_b32 s37, v21
    s_cmp_lg_u32 s37, 0
    s_cbranch_scc1 L_fast13
    ds_read_b32 v21, v105
    s_waitcnt vmcnt(11)
    buffer_load_dwordx4 a[52:55], v5, s[44:47], s78 offen offset:1024 nt
    v_mov_b32 v20, 14
    ds_write_b32 v115, v20
    s_waitcnt lgkmcnt(1)
    v_readfirstlane_b32 s37, v21
    s_cmp_lg_u32 s37, 0
    s_cbranch_scc1 L_fast14
    ds_read_b32 v21, v105
    s_waitcnt vmcnt(11)
    buffer_load_dwordx4 a[56:59], v5, s[44:47], s78 offen offset:2048 nt
    v_mov_b32 v20, 15
    ds_write_b32 v115, v20
    s_waitcnt lgkmcnt(1)
    v_readfirstlane_b32 s37, v21
    s_cmp_lg_u32 s37, 0
    s_cbranch_scc1 L_fast15
    ds_read_b32 v21, v105
    s_waitcnt vmcnt(11)
    buffer_load_dwordx4 a[60:63], v5, s[44:47], s78 offen offset:3072 nt
    v_mov_b32 v20, 16
    ds_write_b32 v115, v20
    s_waitcnt lgkmcnt(1)
    v_readfirstlane_b32 s37, v21
    s_cmp_lg_u32 s37, 0
    s_cbranch_scc1 L_fast16
    ds_read_b32 v21, v105
    s_waitcnt vmcnt(11)
    buffer_load_dwordx4 a[64:67], v4, s[48:51], 0 offen nt
    v_mov_b32 v20, 17
    ds_write_b32 v115, v20
    s_waitcnt lgkmcnt(1)
    v_readfirstlane_b32 s37, v21
    s_cmp_lg_u32 s37, 0
    s_cbranch_scc1 L_fast17
    ds_read_b32 v21, v105
    s_waitcnt vmcnt(11)
    buffer_load_dwordx4 a[68:71], v4, s[48:51], 0 offen offset:1024 nt
    v_mov_b32 v20, 18
    ds_write_b32 v115, v20
    s_waitcnt lgkmcnt(1)
    v_readfirstlane_b32 s37, v21
    s_cmp_lg_u32 s37, 0
    s_cbranch_scc1 L_fast18
    ds_read_b32 v21, v105
    s_waitcnt vmcnt(11)
    buffer_load_dwordx4 a[72:75], v4, s[48:51], 0 offen offset:2048 nt
    v_mov_b32 v20, 19
    ds_write_b32 v115, v20
    s_waitcnt lgkmcnt(1)
    v_readfirstlane_b32 s37, v21
    s_cmp_lg_u32 s37, 0
    s_cbranch_scc1 L_fast19
    ds_read_b32 v21, v105
    s_waitcnt vmcnt(11)
    buffer_load_dwordx4 a[76:79], v4, s[48:51], 0 offen offset:3072 nt
    v_mov_b32 v20, 20
    ds_write_b32 v115, v20
    s_waitcnt lgkmcnt(1)
    v_readfirstlane_b32 s37, v21
    s_cmp_lg_u32 s37, 0
    s_cbranch_scc1 L_fast20
    ds_read_b32 v21, v105
    s_waitcnt vmcnt(11)
    buffer_load_dwordx4 a[80:83], v4, s[48:51], s76 offen nt
    v_mov_b32 v20, 21
    ds_write_b32 v115, v20
    s_waitcnt lgkmcnt(1)
    v_readfirstlane_b32 s37, v21
    s_cmp_lg_u32 s37, 0
    s_cbranch_scc1 L_fast21
    ds_read_b32 v21, v105
    s_waitcnt vmcnt(11)
    buffer_load_dwordx4 a[84:87], v4, s[48:51], s76 offen offset:1024 nt
    v_mov_b32 v20, 22
    ds_write_b32 v115, v20
    s_waitcnt lgkmcnt(1)
    v_readfirstlane_b32 s37, v21
    s_cmp_lg_u32 s37, 0
    s_cbranch_scc1 L_fast22
    ds_read_b32 v21, v105
    s_waitcnt vmcnt(11)
    buffer_load_dwordx4 a[88:91], v4, s[48:51], s76 offen offset:2048 nt
    v_mov_b32 v20, 23
    ds_write_b32 v115, v20
    s_waitcnt lgkmcnt(1)
    v_readfirstlane_b32 s37, v21
    s_cmp_lg_u32 s37, 0
    s_cbranch_scc1 L_fast23
    ds_read_b32 v21, v105
    s_waitcnt vmcnt(11)
    buffer_load_dwordx4 a[92:95], v4, s[48:51], s76 offen offset:3072 nt
    v_mov_b32 v20, 24
    ds_write_b32 v115, v20
    s_waitcnt lgkmcnt(1)
    v_readfirstlane_b32 s37, v21
    s_cmp_lg_u32 s37, 0
    s_cbranch_scc1 L_fast24
    ds_read_b32 v21, v105
    s_waitcnt vmcnt(11)
    buffer_load_dwordx4 a[96:99], v4, s[48:51], s77 offen nt
    v_mov_b32 v20, 25
    ds_write_b32 v115, v20
    s_waitcnt lgkmcnt(1)
    v_readfirstlane_b32 s37, v21
    s_cmp_lg_u32 s37, 0
    s_cbranch_scc1 L_fast25
    ds_read_b32 v21, v105
    s_waitcnt vmcnt(11)
    buffer_load_dwordx4 a[100:103], v4, s[48:51], s77 offen offset:1024 nt
    v_mov_b32 v20, 26
    ds_write_b32 v115, v20
    s_waitcnt lgkmcnt(1)
    v_readfirstlane_b32 s37, v21
    s_cmp_lg_u32 s37, 0
    s_cbranch_scc1 L_fast26
    ds_read_b32 v21, v105
    s_waitcnt vmcnt(11)
    buffer_load_dwordx4 a[104:107], v4, s[48:51], s77 offen offset:2048 nt
    v_mov_b32 v20, 27
    ds_write_b32 v115, v20
    s_waitcnt lgkmcnt(1)
    v_readfirstlane_b32 s37, v21
    s_cmp_lg_u32 s37, 0
    s_cbranch_scc1 L_fast27
    ds_read_b32 v21, v105
    s_waitcnt vmcnt(11)
    buffer_load_dwordx4 a[108:111], v4, s[48:51], s77 offen offset:3072 nt
    v_mov_b32 v20, 28
    ds_write_b32 v115, v20
    s_waitcnt lgkmcnt(1)
    v_readfirstlane_b32 s37, v21
    s_cmp_lg_u32 s37, 0
    s_cbranch_scc1 L_fast28
    ds_read_b32 v21, v105
    s_waitcnt vmcnt(11)
    buffer_load_dwordx4 a[112:115], v4, s[48:51], s78 offen nt
    v_mov_b32 v20, 29
    ds_write_b32 v115, v20
    s_waitcnt lgkmcnt(1)
    v_readfirstlane_b32 s37, v21
    s_cmp_lg_u32 s37, 0
    s_cbranch_scc1 L_fast29
    ds_read_b32 v21, v105
    s_waitcnt vmcnt(11)
    buffer_load_dwordx4 a[116:119], v4, s[48:51], s78 offen offset:1024 nt
    v_mov_b32 v20, 30
    ds_write_b32 v115, v20
    s_waitcnt lgkmcnt(1)
    v_readfirstlane_b32 s37, v21
    s_cmp_lg_u32 s37, 0
    s_cbranch_scc1 L_fast30
    ds_read_b32 v21, v105
    s_waitcnt vmcnt(11)
    buffer_load_dwordx4 a[120:123], v4, s[48:51], s78 offen offset:2048 nt
    v_mov_b32 v20, 31
    ds_write_b32 v115, v20
    s_waitcnt lgkmcnt(1)
    v_readfirstlane_b32 s37, v21
    s_cmp_lg_u32 s37, 0
    s_cbranch_scc1 L_fast31
    ds_read_b32 v21, v105
    s_waitcnt vmcnt(11)
    buffer_load_dwordx4 a[124:127], v4, s[48:51], s78 offen offset:3072 nt
    v_mov_b32 v20, 32
    ds_write_b32 v115, v20
    s_branch L_kvdone
L_fast13:
    buffer_load_dwordx4 a[52:55], v5, s[44:47], s78 offen offset:1024 nt
L_fast14:
    buffer_load_dwordx4 a[56:59], v5, s[44:47], s78 offen offset:2048 nt
L_fast15:
    buffer_load_dwordx4 a[60:63], v5, s[44:47], s78 offen offset:3072 nt
L_fast16:
    s_waitcnt vmcnt(15)
    buffer_load_dwordx4 a[64:67], v4, s[48:51], 0 offen nt
L_fast17:
    s_waitcnt vmcnt(15)
    buffer_load_dwordx4 a[68:71], v4, s[48:51], 0 offen offset:1024 nt
L_fast18:
    s_waitcnt vmcnt(15)
    buffer_load_dwordx4 a[72:75], v4, s[48:51], 0 offen offset:2048 nt
L_fast19:
    s_waitcnt vmcnt(15)
    buffer_load_dwordx4 a[76:79], v4, s[48:51], 0 offen offset:3072 nt
L_fast20:
    s_waitcnt vmcnt(15)
    buffer_load_dwordx4 a[80:83], v4, s[48:51], s76 offen nt
L_fast21:
    s_waitcnt vmcnt(15)
    buffer_load_dwordx4 a[84:87], v4, s[48:51], s76 offen offset:1024 nt
L_fast22:
    s_waitcnt vmcnt(15)
    buffer_load_dwordx4 a[88:91], v4, s[48:51], s76 offen offset:2048 nt
L_fast23:
    s_waitcnt vmcnt(15)
    buffer_load_dwordx4 a[92:95], v4, s[48:51], s76 offen offset:3072 nt
L_fast24:
    s_waitcnt vmcnt(15)
    buffer_load_dwordx4 a[96:99], v4, s[48:51], s77 offen nt
L_fast25:
    s_waitcnt vmcnt(15)
    buffer_load_dwordx4 a[100:103], v4, s[48:51], s77 offen offset:1024 nt
L_fast26:
    s_waitcnt vmcnt(15)
    buffer_load_dwordx4 a[104:107], v4, s[48:51], s77 offen offset:2048 nt
L_fast27:
    s_waitcnt vmcnt(15)
    buffer_load_dwordx4 a[108:111], v4, s[48:51], s77 offen offset:3072 nt
L_fast28:
    s_waitcnt vmcnt(15)
    buffer_load_dwordx4 a[112:115], v4, s[48:51], s78 offen nt
L_fast29:
    s_waitcnt vmcnt(15)
    buffer_load_dwordx4 a[116:119], v4, s[48:51], s78 offen offset:1024 nt
L_fast30:
    s_waitcnt vmcnt(15)
    buffer_load_dwordx4 a[120:123], v4, s[48:51], s78 offen offset:2048 nt
L_fast31:
    s_waitcnt vmcnt(15)
    buffer_load_dwordx4 a[124:127], v4, s[48:51], s78 offen offset:3072 nt
L_kvdone:
    v_mov_b32 v20, 0x7fffffff
    ds_write_b32 v115, v20
    s_barrier
    ds_read_b128 v[26:29], v108 offset:0
    s_waitcnt vmcnt(16) lgkmcnt(0)
    v_mfma_f32_16x16x32_bf16 v[70:73], a[0:3], v[26:29], 0
    v_mfma_f32_16x16x32_bf16 v[74:77], a[4:7], v[26:29], 0
    v_mfma_f32_16x16x32_bf16 v[78:81], a[8:11], v[26:29], 0
    v_mfma_f32_16x16x32_bf16 v[82:85], a[12:15], v[26:29], 0
    v_mfma_f32_16x16x32_bf16 v[86:89], a[16:19], v[26:29], 0
    v_mfma_f32_16x16x32_bf16 v[90:93], a[20:23], v[26:29], 0
    v_mfma_f32_16x16x32_bf16 v[94:97], a[24:27], v[26:29], 0
    v_mfma_f32_16x16x32_bf16 v[98:101], a[28:31], v[26:29], 0
    s_nop 3
    v_mov_b32_dpp v42, v70 quad_perm:[0,0,0,0] row_mask:0xf bank_mask:0xf
    v_mov_b32_dpp v43, v74 quad_perm:[0,0,0,0] row_mask:0xf bank_mask:0xf
    v_mov_b32_dpp v44, v78 quad_perm:[0,0,0,0] row_mask:0xf bank_mask:0xf
    v_mov_b32_dpp v45, v82 quad_perm:[0,0,0,0] row_mask:0xf bank_mask:0xf
    v_add_f32_dpp v42, v71, v42 quad_perm:[1,1,1,1] row_mask:0xf bank_mask:0xf
    v_add_f32_dpp v43, v75, v43 quad_perm:[1,1,1,1] row_mask:0xf bank_mask:0xf
    v_add_f32_dpp v44, v79, v44 quad_perm:[1,1,1,1] row_mask:0xf bank_mask:0xf
    v_add_f32_dpp v45, v83, v45 quad_perm:[1,1,1,1] row_mask:0xf bank_mask:0xf
    v_add_f32_dpp v42, v72, v42 quad_perm:[2,2,2,2] row_mask:0xf bank_mask:0xf
    v_add_f32_dpp v43, v76, v43 quad_perm:[2,2,2,2] row_mask:0xf bank_mask:0xf
    v_add_f32_dpp v44, v80, v44 quad_perm:[2,2,2,2] row_mask:0xf bank_mask:0xf
    v_add_f32_dpp v45, v84, v45 quad_perm:[2,2,2,2] row_mask:0xf bank_mask:0xf
    v_add_f32_dpp v42, v73, v42 quad_perm:[3,3,3,3] row_mask:0xf bank_mask:0xf
    v_add_f32_dpp v43, v77, v43 quad_perm:[3,3,3,3] row_mask:0xf bank_mask:0xf
    v_add_f32_dpp v44, v81, v44 quad_perm:[3,3,3,3] row_mask:0xf bank_mask:0xf
    v_add_f32_dpp v45, v85, v45 quad_perm:[3,3,3,3] row_mask:0xf bank_mask:0xf
    v_mov_b32_dpp v46, v86 quad_perm:[0,0,0,0] row_mask:0xf bank_mask:0xf
    v_mov_b32_dpp v47, v90 quad_perm:[0,0,0,0] row_mask:0xf bank_mask:0xf
    v_mov_b32_dpp v48, v94 quad_perm:[0,0,0,0] row_mask:0xf bank_mask:0xf
    v_mov_b32_dpp v49, v98 quad_perm:[0,0,0,0] row_mask:0xf bank_mask:0xf
    v_add_f32_dpp v46, v87, v46 quad_perm:[1,1,1,1] row_mask:0xf bank_mask:0xf
    v_add_f32_dpp v47, v91, v47 quad_perm:[1,1,1,1] row_mask:0xf bank_mask:0xf
    v_add_f32_dpp v48, v95, v48 quad_perm:[1,1,1,1] row_mask:0xf bank_mask:0xf
    v_add_f32_dpp v49, v99, v49 quad_perm:[1,1,1,1] row_mask:0xf bank_mask:0xf
    v_add_f32_dpp v46, v88, v46 quad_perm:[2,2,2,2] row_mask:0xf bank_mask:0xf
    v_add_f32_dpp v47, v92, v47 quad_perm:[2,2,2,2] row_mask:0xf bank_mask:0xf
    v_add_f32_dpp v48, v96, v48 quad_perm:[2,2,2,2] row_mask:0xf bank_mask:0xf
    v_add_f32_dpp v49, v100, v49 quad_perm:[2,2,2,2] row_mask:0xf bank_mask:0xf
    v_add_f32_dpp v46, v89, v46 quad_perm:[3,3,3,3] row_mask:0xf bank_mask:0xf
    v_add_f32_dpp v47, v93, v47 quad_perm:[3,3,3,3] row_mask:0xf bank_mask:0xf
    v_add_f32_dpp v48, v97, v48 quad_perm:[3,3,3,3] row_mask:0xf bank_mask:0xf
    v_add_f32_dpp v49, v101, v49 quad_perm:[3,3,3,3] row_mask:0xf bank_mask:0xf
    v_mfma_f32_16x16x32_bf16 v[70:73], a[32:35], v[26:29], 0
    v_mfma_f32_16x16x32_bf16 v[74:77], a[36:39], v[26:29], 0
    v_mfma_f32_16x16x32_bf16 v[78:81], a[40:43], v[26:29], 0
    v_mfma_f32_16x16x32_bf16 v[82:85], a[44:47], v[26:29], 0
    v_mfma_f32_16x16x32_bf16 v[86:89], a[48:51], v[26:29], 0
    v_mfma_f32_16x16x32_bf16 v[90:93], a[52:55], v[26:29], 0
    v_mfma_f32_16x16x32_bf16 v[94:97], a[56:59], v[26:29], 0
    v_mfma_f32_16x16x32_bf16 v[98:101], a[60:63], v[26:29], 0
    s_nop 3
    v_mov_b32_dpp v50, v70 quad_perm:[0,0,0,0] row_mask:0xf bank_mask:0xf
    v_mov_b32_dpp v51, v74 quad_perm:[0,0,0,0] row_mask:0xf bank_mask:0xf
    v_mov_b32_dpp v52, v78 quad_perm:[0,0,0,0] row_mask:0xf bank_mask:0xf
    v_mov_b32_dpp v53, v82 quad_perm:[0,0,0,0] row_mask:0xf bank_mask:0xf
    v_add_f32_dpp v50, v71, v50 quad_perm:[1,1,1,1] row_mask:0xf bank_mask:0xf
    v_add_f32_dpp v51, v75, v51 quad_perm:[1,1,1,1] row_mask:0xf bank_mask:0xf
    v_add_f32_dpp v52, v79, v52 quad_perm:[1,1,1,1] row_mask:0xf bank_mask:0xf
    v_add_f32_dpp v53, v83, v53 quad_perm:[1,1,1,1] row_mask:0xf bank_mask:0xf
    v_add_f32_dpp v50, v72, v50 quad_perm:[2,2,2,2] row_mask:0xf bank_mask:0xf
    v_add_f32_dpp v51, v76, v51 quad_perm:[2,2,2,2] row_mask:0xf bank_mask:0xf
    v_add_f32_dpp v52, v80, v52 quad_perm:[2,2,2,2] row_mask:0xf bank_mask:0xf
    v_add_f32_dpp v53, v84, v53 quad_perm:[2,2,2,2] row_mask:0xf bank_mask:0xf
    v_add_f32_dpp v50, v73, v50 quad_perm:[3,3,3,3] row_mask:0xf bank_mask:0xf
    v_add_f32_dpp v51, v77, v51 quad_perm:[3,3,3,3] row_mask:0xf bank_mask:0xf
    v_add_f32_dpp v52, v81, v52 quad_perm:[3,3,3,3] row_mask:0xf bank_mask:0xf
    v_add_f32_dpp v53, v85, v53 quad_perm:[3,3,3,3] row_mask:0xf bank_mask:0xf
    v_mov_b32_dpp v54, v86 quad_perm:[0,0,0,0] row_mask:0xf bank_mask:0xf
    v_mov_b32_dpp v55, v90 quad_perm:[0,0,0,0] row_mask:0xf bank_mask:0xf
    v_mov_b32_dpp v56, v94 quad_perm:[0,0,0,0] row_mask:0xf bank_mask:0xf
    v_mov_b32_dpp v57, v98 quad_perm:[0,0,0,0] row_mask:0xf bank_mask:0xf
    v_add_f32_dpp v54, v87, v54 quad_perm:[1,1,1,1] row_mask:0xf bank_mask:0xf
    v_add_f32_dpp v55, v91, v55 quad_perm:[1,1,1,1] row_mask:0xf bank_mask:0xf
    v_add_f32_dpp v56, v95, v56 quad_perm:[1,1,1,1] row_mask:0xf bank_mask:0xf
    v_add_f32_dpp v57, v99, v57 quad_perm:[1,1,1,1] row_mask:0xf bank_mask:0xf
    v_add_f32_dpp v54, v88, v54 quad_perm:[2,2,2,2] row_mask:0xf bank_mask:0xf
    v_add_f32_dpp v55, v92, v55 quad_perm:[2,2,2,2] row_mask:0xf bank_mask:0xf
    v_add_f32_dpp v56, v96, v56 quad_perm:[2,2,2,2] row_mask:0xf bank_mask:0xf
    v_add_f32_dpp v57, v100, v57 quad_perm:[2,2,2,2] row_mask:0xf bank_mask:0xf
    v_add_f32_dpp v54, v89, v54 quad_perm:[3,3,3,3] row_mask:0xf bank_mask:0xf
    v_add_f32_dpp v55, v93, v55 quad_perm:[3,3,3,3] row_mask:0xf bank_mask:0xf
    v_add_f32_dpp v56, v97, v56 quad_perm:[3,3,3,3] row_mask:0xf bank_mask:0xf
    v_add_f32_dpp v57, v101, v57 quad_perm:[3,3,3,3] row_mask:0xf bank_mask:0xf
    v_max3_f32 v18, v42, v43, v44
    v_max3_f32 v18, v18, v45, v46
    v_max3_f32 v18, v18, v47, v48
    v_max3_f32 v18, v18, v49, v50
    v_max3_f32 v18, v18, v51, v52
    v_max3_f32 v18, v18, v53, v54
    v_max3_f32 v18, v18, v55, v56
    v_max_f32 v18, v18, v57
    v_mov_b32 v20, v18
    s_nop 1
    v_permlane16_swap_b32 v18, v20
    s_nop 1
    v_max_f32 v18, v18, v20
    v_mov_b32 v20, v18
    s_nop 1
    v_permlane32_swap_b32 v18, v20
    s_nop 1
    v_max_f32 v18, v18, v20
    s_lshl_b32 s37, s26, 2
    v_add_u32 v26, s37, v112
    ds_write_b32 v26, v18 offset:1088
L_m_retry:
    s_sub_u32 s96, s96, 1
    s_cbranch_scc1 L_m_ok
    ds_read_b128 v[70:73], v112 offset:1088
    s_waitcnt lgkmcnt(0)
    v_max3_u32 v20, v70, v71, v72
    v_max_u32 v20, v20, v73
    v_cmp_eq_u32 vcc, -1, v20
    s_cbranch_vccnz L_m_retry
L_m_ok:
    v_max3_f32 v18, v70, v71, v72
    v_max_f32 v18, v18, v73
    v_mul_f32 v18, s36, v18
    v_fma_f32 v42, v42, s36, -v18
    v_fma_f32 v43, v43, s36, -v18
    v_fma_f32 v44, v44, s36, -v18
    v_fma_f32 v45, v45, s36, -v18
    v_exp_f32 v42, v42
    v_exp_f32 v43, v43
    v_exp_f32 v44, v44
    v_exp_f32 v45, v45
    v_cvt_pk_bf16_f32 v70, v42, v42
    v_cvt_pk_bf16_f32 v71, v43, v43
    v_cvt_pk_bf16_f32 v72, v44, v44
    v_cvt_pk_bf16_f32 v73, v45, v45
    v_fma_f32 v46, v46, s36, -v18
    v_fma_f32 v47, v47, s36, -v18
    v_fma_f32 v48, v48, s36, -v18
    v_fma_f32 v49, v49, s36, -v18
    v_exp_f32 v46, v46
    v_exp_f32 v47, v47
    v_exp_f32 v48, v48
    v_exp_f32 v49, v49
    v_cvt_pk_bf16_f32 v74, v46, v46
    v_cvt_pk_bf16_f32 v75, v47, v47
    v_cvt_pk_bf16_f32 v76, v48, v48
    v_cvt_pk_bf16_f32 v77, v49, v49
    v_fma_f32 v50, v50, s36, -v18
    v_fma_f32 v51, v51, s36, -v18
    v_fma_f32 v52, v52, s36, -v18
    v_fma_f32 v53, v53, s36, -v18
    v_exp_f32 v50, v50
    v_exp_f32 v51, v51
    v_exp_f32 v52, v52
    v_exp_f32 v53, v53
    v_cvt_pk_bf16_f32 v78, v50, v50
    v_cvt_pk_bf16_f32 v79, v51, v51
    v_cvt_pk_bf16_f32 v80, v52, v52
    v_cvt_pk_bf16_f32 v81, v53, v53
    v_fma_f32 v54, v54, s36, -v18
    v_fma_f32 v55, v55, s36, -v18
    v_fma_f32 v56, v56, s36, -v18
    v_fma_f32 v57, v57, s36, -v18
    v_exp_f32 v54, v54
    v_exp_f32 v55, v55
    v_exp_f32 v56, v56
    v_exp_f32 v57, v57
    v_cvt_pk_bf16_f32 v82, v54, v54
    v_cvt_pk_bf16_f32 v83, v55, v55
    v_cvt_pk_bf16_f32 v84, v56, v56
    v_cvt_pk_bf16_f32 v85, v57, v57
    v_and_b32 v60, v70, v16
    v_and_b32 v61, v70, v17
    v_and_b32 v66, v71, v16
    v_and_b32 v67, v71, v17
    s_waitcnt vmcnt(15)
    v_mfma_f32_16x16x32_bf16 v[30:33], v[60:63], a[64:67], 0
    v_mfma_f32_16x16x32_bf16 v[34:37], v[58:61], a[64:67], 0
    v_and_b32 v60, v72, v16
    v_and_b32 v61, v72, v17
    s_waitcnt vmcnt(14)
    v_mfma_f32_16x16x32_bf16 v[30:33], v[66:69], a[68:71], v[30:33]
    v_mfma_f32_16x16x32_bf16 v[34:37], v[64:67], a[68:71], v[34:37]
    v_add_f32 v19, v42, v43
    v_and_b32 v66, v73, v16
    v_and_b32 v67, v73, v17
    s_waitcnt vmcnt(13)
    v_mfma_f32_16x16x32_bf16 v[30:33], v[60:63], a[72:75], v[30:33]
    v_mfma_f32_16x16x32_bf16 v[34:37], v[58:61], a[72:75], v[34:37]
    v_add_f32 v19, v19, v44
    v_add_f32 v19, v19, v45
    v_and_b32 v60, v74, v16
    v_and_b32 v61, v74, v17
    s_waitcnt vmcnt(12)
    v_mfma_f32_16x16x32_bf16 v[30:33], v[66:69], a[76:79], v[30:33]
    v_mfma_f32_16x16x32_bf16 v[34:37], v[64:67], a[76:79], v[34:37]
    v_add_f32 v19, v19, v46
    v_add_f32 v19, v19, v47
    v_and_b32 v66, v75, v16
    v_and_b32 v67, v75, v17
    s_waitcnt vmcnt(11)
    v_mfma_f32_16x16x32_bf16 v[30:33], v[60:63], a[80:83], v[30:33]
    v_mfma_f32_16x16x32_bf16 v[34:37], v[58:61], a[80:83], v[34:37]
    v_add_f32 v19, v19, v48
    v_add_f32 v19, v19, v49
    v_and_b32 v60, v76, v16
    v_and_b32 v61, v76, v17
    s_waitcnt vmcnt(10)
    v_mfma_f32_16x16x32_bf16 v[30:33], v[66:69], a[84:87], v[30:33]
    v_mfma_f32_16x16x32_bf16 v[34:37], v[64:67], a[84:87], v[34:37]
    v_add_f32 v19, v19, v50
    v_add_f32 v19, v19, v51
    v_and_b32 v66, v77, v16
    v_and_b32 v67, v77, v17
    s_waitcnt vmcnt(9)
    v_mfma_f32_16x16x32_bf16 v[30:33], v[60:63], a[88:91], v[30:33]
    v_mfma_f32_16x16x32_bf16 v[34:37], v[58:61], a[88:91], v[34:37]
    v_add_f32 v19, v19, v52
    v_add_f32 v19, v19, v53
    v_and_b32 v60, v78, v16
    v_and_b32 v61, v78, v17
    s_waitcnt vmcnt(8)
    v_mfma_f32_16x16x32_bf16 v[30:33], v[66:69], a[92:95], v[30:33]
    v_mfma_f32_16x16x32_bf16 v[34:37], v[64:67], a[92:95], v[34:37]
    v_add_f32 v19, v19, v54
    v_add_f32 v19, v19, v55
    v_and_b32 v66, v79, v16
    v_and_b32 v67, v79, v17
    s_waitcnt vmcnt(7)
    v_mfma_f32_16x16x32_bf16 v[30:33], v[60:63], a[96:99], v[30:33]
    v_mfma_f32_16x16x32_bf16 v[34:37], v[58:61], a[96:99], v[34:37]
    v_add_f32 v19, v19, v56
    v_add_f32 v19, v19, v57
    v_and_b32 v60, v80, v16
    v_and_b32 v61, v80, v17
    s_waitcnt vmcnt(6)
    v_mfma_f32_16x16x32_bf16 v[30:33], v[66:69], a[100:103], v[30:33]
    v_mfma_f32_16x16x32_bf16 v[34:37], v[64:67], a[100:103], v[34:37]
    v_mov_b32 v20, v19
    s_nop 1
    v_permlane16_swap_b32 v19, v20
    s_nop 1
    v_add_f32 v19, v19, v20
    v_mov_b32 v20, v19
    s_nop 1
    v_permlane32_swap_b32 v19, v20
    s_nop 1
    v_add_f32 v19, v19, v20
    ds_write_b32 v26, v19 offset:1152
    v_and_b32 v66, v81, v16
    v_and_b32 v67, v81, v17
    s_waitcnt vmcnt(5)
    v_mfma_f32_16x16x32_bf16 v[30:33], v[60:63], a[104:107], v[30:33]
    v_mfma_f32_16x16x32_bf16 v[34:37], v[58:61], a[104:107], v[34:37]
    v_and_b32 v60, v82, v16
    v_and_b32 v61, v82, v17
    s_waitcnt vmcnt(4)
    v_mfma_f32_16x16x32_bf16 v[30:33], v[66:69], a[108:111], v[30:33]
    v_mfma_f32_16x16x32_bf16 v[34:37], v[64:67], a[108:111], v[34:37]
    v_and_b32 v66, v83, v16
    v_and_b32 v67, v83, v17
    s_waitcnt vmcnt(3)
    v_mfma_f32_16x16x32_bf16 v[30:33], v[60:63], a[112:115], v[30:33]
    v_mfma_f32_16x16x32_bf16 v[34:37], v[58:61], a[112:115], v[34:37]
    v_and_b32 v60, v84, v16
    v_and_b32 v61, v84, v17
    s_waitcnt vmcnt(2)
    v_mfma_f32_16x16x32_bf16 v[30:33], v[66:69], a[116:119], v[30:33]
    v_mfma_f32_16x16x32_bf16 v[34:37], v[64:67], a[116:119], v[34:37]
    v_and_b32 v66, v85, v16
    v_and_b32 v67, v85, v17
    s_waitcnt vmcnt(1)
    v_mfma_f32_16x16x32_bf16 v[30:33], v[60:63], a[120:123], v[30:33]
    v_mfma_f32_16x16x32_bf16 v[34:37], v[58:61], a[120:123], v[34:37]
    s_nop 1
    s_waitcnt vmcnt(0)
    v_mfma_f32_16x16x32_bf16 v[30:33], v[66:69], a[124:127], v[30:33]
    v_mfma_f32_16x16x32_bf16 v[34:37], v[64:67], a[124:127], v[34:37]
    s_nop 7
    ds_write_b128 v109, v[30:33]
    ds_write_b128 v109, v[34:37] offset:16
    s_waitcnt lgkmcnt(0)
    s_barrier
    s_cmp_ge_u32 s26, 2
    s_cbranch_scc1 L_o_stats
    ds_read_b128 v[70:73], v114 offset:0
    ds_read_b128 v[74:77], v114 offset:2048
    ds_read_b128 v[78:81], v114 offset:4096
    ds_read_b128 v[82:85], v114 offset:6144
    s_waitcnt lgkmcnt(2)
    v_add_f32 v70, v70, v74
    v_add_f32 v71, v71, v75
    v_add_f32 v72, v72, v76
    v_add_f32 v73, v73, v77
    s_waitcnt lgkmcnt(0)
    v_add_f32 v78, v78, v82
    v_add_f32 v79, v79, v83
    v_add_f32 v80, v80, v84
    v_add_f32 v81, v81, v85
    v_add_f32 v70, v70, v78
    v_add_f32 v71, v71, v79
    v_add_f32 v72, v72, v80
    v_add_f32 v73, v73, v81
    v_bfi_b32 v70, s34, v23, v70
    v_bfi_b32 v71, s34, v23, v71
    v_bfi_b32 v72, s34, v23, v72
    v_bfi_b32 v73, s34, v23, v73
    buffer_store_dwordx4 v[70:73], v102, s[60:63], 0 offen
    s_branch L_o_done
L_o_stats:
    ds_read_b128 v[74:77], v112 offset:1152
    s_waitcnt lgkmcnt(0)
    v_add_f32 v74, v74, v75
    v_add_f32 v76, v76, v77
    v_mov_b32 v70, v18
    v_add_f32 v71, v74, v76
    v_mov_b32 v72, s33
    v_mov_b32 v73, s33
    s_mov_b64 exec, 0x1111
    buffer_store_dwordx4 v[70:73], v102, s[60:63], 0 offen
    s_mov_b64 exec, -1
L_o_done:
    buffer_load_dwordx4 v[94:97], v104, s[60:63], s80 offen sc1
    buffer_load_dwordx4 v[86:89], v103, s[60:63], s80 offen sc1
    buffer_load_dwordx4 v[90:93], v103, s[60:63], s97 offen sc1
    s_mov_b64 exec, s[70:71]
    buffer_store_dwordx4 v[70:73], v102, s[60:63], s79 offen sc1
    s_mov_b64 exec, -1
    s_barrier
    ds_read_b64_tr_b16 v[38:39], v116 offset:0
    ds_read_b64_tr_b16 v[40:41], v116 offset:1024
    ds_read_b64_tr_b16 v[42:43], v116 offset:8192
    ds_read_b64_tr_b16 v[44:45], v116 offset:9216
    ds_read_b64_tr_b16 v[46:47], v116 offset:16384
    ds_read_b64_tr_b16 v[48:49], v116 offset:17408
    ds_read_b64_tr_b16 v[50:51], v116 offset:24576
    ds_read_b64_tr_b16 v[52:53], v116 offset:25600
    ds_read_b64_tr_b16 v[54:55], v117 offset:0
    ds_read_b64_tr_b16 v[56:57], v117 offset:1024
    ds_read_b64_tr_b16 v[58:59], v117 offset:8192
    ds_read_b64_tr_b16 v[60:61], v117 offset:9216
    ds_read_b64_tr_b16 v[62:63], v117 offset:16384
    ds_read_b64_tr_b16 v[64:65], v117 offset:17408
    ds_read_b64_tr_b16 v[66:67], v117 offset:24576
    ds_read_b64_tr_b16 v[68:69], v117 offset:25600
    s_waitcnt vmcnt(1)
    s_branch L_o_chk
L_o_retry:
    s_sub_u32 s96, s96, 1
    s_cbranch_scc1 L_o_ok
    s_sub_u32 s92, s92, 1
    s_cbranch_scc0 L_o_noalt
    s_or_b32 s80, s80, 2097152
    s_or_b32 s97, s97, 2097152
L_o_noalt:
    buffer_load_dwordx4 v[94:97], v104, s[60:63], s80 offen sc1
    buffer_load_dwordx4 v[86:89], v103, s[60:63], s80 offen sc1
    buffer_load_dwordx4 v[90:93], v103, s[60:63], s97 offen sc1
    s_waitcnt vmcnt(0)
L_o_chk:
    v_xor_b32 v20, s35, v86
    v_xor_b32 v21, s35, v87
    v_xor_b32 v22, s35, v88
    v_or3_b32 v20, v20, v21, v22
    v_xor_b32 v21, s35, v89
    v_xor_b32 v22, s35, v90
    v_or3_b32 v20, v20, v21, v22
    v_xor_b32 v21, s35, v91
    v_xor_b32 v22, s35, v92
    v_or3_b32 v20, v20, v21, v22
    v_xor_b32 v21, s35, v93
    v_or_b32 v20, v20, v21
    v_and_b32 v20, s34, v20
    v_xor_b32 v21, s33, v96
    v_xor_b32 v22, s33, v97
    v_or3_b32 v20, v20, v21, v22
    v_cmp_ne_u32 vcc, 0, v20
    s_cbranch_vccnz L_o_retry
L_o_ok:
    v_max_f32_dpp v70, v94, v94 quad_perm:[1,0,3,2] row_mask:0xf bank_mask:0xf
    s_nop 1
    v_max_f32_dpp v70, v70, v70 quad_perm:[2,3,0,1] row_mask:0xf bank_mask:0xf
    s_nop 1
    v_max_f32_dpp v70, v70, v70 row_half_mirror row_mask:0xf bank_mask:0xf
    v_sub_f32 v71, v94, v70
    v_exp_f32 v71, v71
    s_nop 0
    v_mul_f32 v72, v71, v95
    v_mul_f32_dpp v78, v71, v86 row_newbcast:0 row_mask:0xf bank_mask:0xf
    v_mul_f32_dpp v79, v71, v87 row_newbcast:0 row_mask:0xf bank_mask:0xf
    v_add_f32_dpp v72, v72, v72 quad_perm:[1,0,3,2] row_mask:0xf bank_mask:0xf
    v_mul_f32_dpp v80, v71, v88 row_newbcast:0 row_mask:0xf bank_mask:0xf
    v_mul_f32_dpp v81, v71, v89 row_newbcast:0 row_mask:0xf bank_mask:0xf
    v_add_f32_dpp v72, v72, v72 quad_perm:[2,3,0,1] row_mask:0xf bank_mask:0xf
    v_fmac_f32_dpp v78, v71, v90 row_newbcast:4 row_mask:0xf bank_mask:0xf
    v_fmac_f32_dpp v79, v71, v91 row_newbcast:4 row_mask:0xf bank_mask:0xf
    v_add_f32_dpp v72, v72, v72 row_half_mirror row_mask:0xf bank_mask:0xf
    v_fmac_f32_dpp v80, v71, v92 row_newbcast:4 row_mask:0xf bank_mask:0xf
    v_fmac_f32_dpp v81, v71, v93 row_newbcast:4 row_mask:0xf bank_mask:0xf
    v_rcp_f32 v72, v72
    v_mov_b32 v82, v78
    v_mov_b32 v83, v79
    v_mov_b32 v84, v80
    v_mov_b32 v85, v81
    v_permlane16_swap_b32 v78, v82
    v_permlane16_swap_b32 v79, v83
    v_permlane16_swap_b32 v80, v84
    v_permlane16_swap_b32 v81, v85
    v_add_f32 v78, v78, v82
    v_add_f32 v79, v79, v83
    v_add_f32 v80, v80, v84
    v_add_f32 v81, v81, v85
    v_mov_b32 v82, v78
    v_mov_b32 v83, v79
    v_mov_b32 v84, v80
    v_mov_b32 v85, v81
    v_permlane32_swap_b32 v78, v82
    v_permlane32_swap_b32 v79, v83
    v_permlane32_swap_b32 v80, v84
    v_permlane32_swap_b32 v81, v85
    v_add_f32 v78, v78, v82
    v_add_f32 v79, v79, v83
    v_add_f32 v80, v80, v84
    v_add_f32 v81, v81, v85
    v_mul_f32 v78, v78, v72
    v_mul_f32 v79, v79, v72
    v_mul_f32 v80, v80, v72
    v_mul_f32 v81, v81, v72
    v_cvt_pk_bf16_f32 v70, v78, v79
    v_cvt_pk_bf16_f32 v71, v80, v81
    s_mov_b64 exec, 0xffff
    ds_write_b64 v111, v[70:71]
    s_mov_b64 exec, -1
    s_waitcnt lgkmcnt(0)
    s_barrier
    ds_read_b128 v[70:73], v110 offset:0
    ds_read_b128 v[74:77], v110 offset:64
    ds_read_b128 v[78:81], v110 offset:128
    ds_read_b128 v[82:85], v110 offset:192
    s_waitcnt lgkmcnt(3)
    v_mfma_f32_16x16x32_bf16 v[30:33], v[38:41], v[70:73], 0
    v_mfma_f32_16x16x32_bf16 v[34:37], v[54:57], v[70:73], 0
    s_waitcnt lgkmcnt(2)
    v_mfma_f32_16x16x32_bf16 v[30:33], v[42:45], v[74:77], v[30:33]
    v_mfma_f32_16x16x32_bf16 v[34:37], v[58:61], v[74:77], v[34:37]
    s_waitcnt lgkmcnt(1)
    v_mfma_f32_16x16x32_bf16 v[30:33], v[46:49], v[78:81], v[30:33]
    v_mfma_f32_16x16x32_bf16 v[34:37], v[62:65], v[78:81], v[34:37]
    s_waitcnt lgkmcnt(0)
    v_mfma_f32_16x16x32_bf16 v[30:33], v[50:53], v[82:85], v[30:33]
    v_mfma_f32_16x16x32_bf16 v[34:37], v[66:69], v[82:85], v[34:37]
    s_mov_b32 exec_lo, 0x00030003
    s_mov_b32 exec_hi, 0x00030003
    s_nop 5
    v_bfi_b32 v30, s34, v23, v30
    v_bfi_b32 v31, s34, v23, v31
    v_bfi_b32 v32, s34, v23, v32
    v_bfi_b32 v33, s34, v23, v33
    buffer_store_dwordx4 v[30:33], v106, s[60:63], 0 offen sc1
    v_bfi_b32 v34, s34, v23, v34
    v_bfi_b32 v35, s34, v23, v35
    v_bfi_b32 v36, s34, v23, v36
    v_bfi_b32 v37, s34, v23, v37
    buffer_store_dwordx4 v[34:37], v106, s[60:63], 0 offen offset:64 sc1
    s_mov_b64 exec, -1
    s_cmp_lg_u32 s26, 0
    s_cbranch_scc1 L_fin
L_p_retry:
    s_sub_u32 s96, s96, 1
    s_cbranch_scc1 L_p_ok
    buffer_load_dwordx4 v[86:89], v107, s[60:63], 0 offen sc1
    s_waitcnt vmcnt(0)
    v_xor_b32 v20, s35, v86
    v_xor_b32 v21, s35, v87
    v_xor_b32 v22, s35, v88
    v_or3_b32 v20, v20, v21, v22
    v_xor_b32 v21, s35, v89
    v_or_b32 v20, v20, v21
    v_and_b32 v20, s34, v20
    v_cmp_ne_u32 vcc, 0, v20
    s_cbranch_vccnz L_p_retry
L_p_ok:
    v_add_f32_dpp v86, v86, v86 quad_perm:[2,3,0,1] row_mask:0xf bank_mask:0xf
    v_add_f32_dpp v87, v87, v87 quad_perm:[2,3,0,1] row_mask:0xf bank_mask:0xf
    v_add_f32_dpp v88, v88, v88 quad_perm:[2,3,0,1] row_mask:0xf bank_mask:0xf
    v_add_f32_dpp v89, v89, v89 quad_perm:[2,3,0,1] row_mask:0xf bank_mask:0xf
    v_add_f32_dpp v86, v86, v86 row_ror:4 row_mask:0xf bank_mask:0xf
    v_add_f32_dpp v87, v87, v87 row_ror:4 row_mask:0xf bank_mask:0xf
    v_add_f32_dpp v88, v88, v88 row_ror:4 row_mask:0xf bank_mask:0xf
    v_add_f32_dpp v89, v89, v89 row_ror:4 row_mask:0xf bank_mask:0xf
    v_add_f32_dpp v86, v86, v86 row_ror:8 row_mask:0xf bank_mask:0xf
    v_add_f32_dpp v87, v87, v87 row_ror:8 row_mask:0xf bank_mask:0xf
    v_add_f32_dpp v88, v88, v88 row_ror:8 row_mask:0xf bank_mask:0xf
    v_add_f32_dpp v89, v89, v89 row_ror:8 row_mask:0xf bank_mask:0xf
    v_mov_b32 v90, v86
    v_mov_b32 v91, v87
    v_mov_b32 v92, v88
    v_mov_b32 v93, v89
    s_nop 0
    v_permlane16_swap_b32 v86, v90
    v_permlane16_swap_b32 v87, v91
    v_permlane16_swap_b32 v88, v92
    v_permlane16_swap_b32 v89, v93
    s_nop 0
    v_add_f32 v86, v86, v90
    v_add_f32 v87, v87, v91
    v_add_f32 v88, v88, v92
    v_add_f32 v89, v89, v93
    v_mov_b32 v90, v86
    v_mov_b32 v91, v87
    v_mov_b32 v92, v88
    v_mov_b32 v93, v89
    s_nop 0
    v_permlane32_swap_b32 v86, v90
    v_permlane32_swap_b32 v87, v91
    v_permlane32_swap_b32 v88, v92
    v_permlane32_swap_b32 v89, v93
    s_nop 0
    v_add_f32 v86, v86, v90
    v_add_f32 v87, v87, v91
    v_add_f32 v88, v88, v92
    v_add_f32 v89, v89, v93
    v_cvt_pk_bf16_f32 v70, v86, v87
    v_cvt_pk_bf16_f32 v71, v88, v89
    s_mov_b64 exec, 3
    buffer_store_dwordx2 v[70:71], v113, s[64:67], 0 offen
    s_and_b32 s37, s2, 0xf7
    s_cmp_lg_u32 s37, 0
    s_cbranch_scc1 L_noep
    s_mov_b64 exec, 1
    s_lshl_b32 s37, s5, 7
    v_mov_b32 v72, s37
    v_mov_b32 v73, s33
    buffer_store_dword v73, v72, s[60:63], 0 offen sc1
L_noep:
    s_mov_b64 exec, -1
L_fin:
L_end:
    s_endpgm
.section .rodata,"a"
.p2align 6
.amdhsa_kernel concat_heads__sliding_block_cached__sliding_block_cached__decode_kernel
  .amdhsa_next_free_vgpr 256
  .amdhsa_next_free_sgpr 102
  .amdhsa_accum_offset 128
  .amdhsa_group_segment_fixed_size 0
  .amdhsa_kernarg_size 104
  .amdhsa_user_sgpr_count 2
  .amdhsa_user_sgpr_kernarg_segment_ptr 1
  .amdhsa_system_sgpr_workgroup_id_x 1
.end_amdhsa_kernel
```
